```python
import torch

def _softmax(x, axis=-1):
    return torch.softmax(x, dim=axis)
def _gelu(x):
    return torch.nn.functional.gelu(x, approximate="tanh")
def _silu(x):
    return torch.nn.functional.silu(x)
def _sigmoid(x):
    return torch.sigmoid(x)
def _layernorm(x, axis=-1, eps=1e-5):
    m = x.mean(dim=axis, keepdim=True)
    v = x.var(dim=axis, keepdim=True, unbiased=False)
    return (x - m) / torch.sqrt(v + eps)
def _scatter_add(tgt, idx, src, axis=0):
    return tgt.clone().index_add_(axis, idx, src)
def _segment_sum(src, seg, n):
    out = torch.zeros((n,) + src.shape[1:], dtype=src.dtype)
    return out.index_add_(0, seg, src)
def _pad(x, pw):
    flat = tuple(v for pair in reversed(pw) for v in pair)
    return torch.nn.functional.pad(x, flat)

kernel_name = 'parallel_sum__gqa_block_cached__geglu_ffn__decode'

def setup_inputs():

    _w = (lambda a: (lambda t: t.to(torch.bfloat16) if t.is_floating_point() else t)(torch.as_tensor(a)))
    def _A_setup():
        B, Sq, D = 4, 1, 640
        Hq, Hkv, Sk, Dh = 32, 32, 4096, 128
        assert Hq % Hkv == 0, (Hq, Hkv)
        return {
            "x": _w((lambda *s: torch.randn(*s, dtype=torch.bfloat16) * 0.05)(B, Sq, D)),
            "k_cache": _w((lambda *s: torch.randn(*s, dtype=torch.bfloat16) * 3.2)(B, Hkv, Sk, Dh)),
            "v_cache": _w((lambda *s: torch.randn(*s, dtype=torch.bfloat16) * 1.6)(B, Hkv, Sk, Dh)),
            "wq": _w((lambda *s: torch.randn(*s, dtype=torch.bfloat16) * 3.2)(D, Hq * Dh) * (D ** -0.5)),
            "wo": _w((lambda *s: torch.randn(*s, dtype=torch.bfloat16) * 1.6)(Hq * Dh, D) * ((Hq * Dh) ** -0.5)),
        }
    _A_in = _A_setup()

    def _B_setup():
        B, S, D, F = 4, 1, 640, 1728
        return {
            "x": _w((lambda *s: torch.randn(*s, dtype=torch.bfloat16) * 0.05)(B, S, D)),
            "w_gate": _w((lambda *s: torch.randn(*s, dtype=torch.bfloat16) * 0.05)(D, F)),
            "w_up": _w((lambda *s: torch.randn(*s, dtype=torch.bfloat16) * 0.05)(D, F)),
            "w_down": _w((lambda *s: torch.randn(*s, dtype=torch.bfloat16) * 0.05)(F, D)),
        }
    _B_in = _B_setup()

    return {
        "A_x": _A_in["x"],
        "A_k_cache": _A_in["k_cache"],
        "A_v_cache": _A_in["v_cache"],
        "A_wq": _A_in["wq"],
        "A_wo": _A_in["wo"],
        "B_x": _B_in["x"],
        "B_w_gate": _B_in["w_gate"],
        "B_w_up": _B_in["w_up"],
        "B_w_down": _B_in["w_down"],
    }

def reference(A_x, A_k_cache, A_v_cache, A_wq, A_wo, B_x, B_w_gate, B_w_up, B_w_down):
    def _A_ref(x, k_cache, v_cache, wq, wo):
        B, Sq, D = x.shape
        Hq, Dh = 32, 128
        Hkv = k_cache.shape[1]
        rep = Hq // Hkv
        q = (lambda x, *d: x.permute(*d))((x @ wq).reshape(B, Sq, Hq, Dh), 0, 2, 1, 3)
        k = (lambda x, n, axis: torch.repeat_interleave(x, n, dim=axis))(k_cache, rep, axis=1)
        v = (lambda x, n, axis: torch.repeat_interleave(x, n, dim=axis))(v_cache, rep, axis=1)
        scores = torch.einsum("bhqd,bhkd->bhqk", q, k) * (Dh ** -0.5)
        p = _softmax(scores, axis=-1)
        o = torch.einsum("bhqk,bhkd->bhqd", p, v)
        return (lambda x, *d: x.permute(*d))(o, 0, 2, 1, 3).reshape(B, Sq, Hq * Dh) @ wo

    def _B_ref(x, w_gate, w_up, w_down):
        return (_gelu(x @ w_gate) * (x @ w_up)) @ w_down

    x = A_x
    xn = _layernorm(x, axis=-1)
    return x + _A_ref(xn, A_k_cache, A_v_cache, A_wq, A_wo) + _B_ref(xn, B_w_gate, B_w_up, B_w_down)
```

```asm
; @launch grid=(256,1,1) block=(512,1,1) lds=53248
.amdgcn_target "amdgcn-amd-amdhsa--gfx950"
.text
.globl parallel_sum__gqa_block_cached__geglu_ffn__decode_kernel
.p2align 8
.type parallel_sum__gqa_block_cached__geglu_ffn__decode_kernel,@function
parallel_sum__gqa_block_cached__geglu_ffn__decode_kernel:
  s_cmp_ge_u32 s2, 256
  s_cbranch_scc1 L_end
  s_load_dwordx2 s[28:29], s[0:1], 0
  s_load_dwordx2 s[40:41], s[0:1], 24
  s_load_dwordx2 s[32:33], s[0:1], 8
  s_load_dwordx2 s[48:49], s[0:1], 48
  s_load_dwordx2 s[52:53], s[0:1], 56
  s_load_dwordx2 s[64:65], s[0:1], 80
  s_load_dwordx2 s[68:69], s[0:1], 88
  s_load_dwordx2 s[36:37], s[0:1], 16
  s_load_dwordx2 s[44:45], s[0:1], 32
  s_load_dwordx2 s[56:57], s[0:1], 64
  s_load_dwordx2 s[60:61], s[0:1], 72
  s_memrealtime s[90:91]
  s_mov_b32 s30, 5120
  s_mov_b32 s31, 0x20000
  s_mov_b32 s42, 5242880
  s_mov_b32 s43, 0x20000
  s_mov_b32 s34, 134217728
  s_mov_b32 s35, 0x20000
  v_and_b32 v1, 63, v0
  v_lshrrev_b32 v42, 6, v0
  v_and_b32 v2, 15, v1
  v_lshrrev_b32 v3, 4, v1
  v_readfirstlane_b32 s72, v42
  s_and_b32 s82, s2, 7
  s_lshr_b32 s83, s2, 3
  s_lshl_b32 s73, s82, 2
  s_lshr_b32 s85, s83, 3
  s_xor_b32 s85, s85, 0
  s_add_u32 s73, s73, s85
  s_and_b32 s20, s83, 7
  s_and_b32 s75, s20, 1
  s_lshr_b32 s74, s20, 1
  s_mul_i32 s82, s82, 0
  s_mul_i32 s83, s83, 1
  s_add_u32 s89, s82, s83
  s_lshr_b32 s89, s89, 0
  s_and_b32 s89, s89, 15
  v_lshlrev_b32 v42, 4, v2
  v_lshl_add_u32 v8, v3, 10, v42
  v_lshl_add_u32 v9, v3, 13, v42
  v_lshlrev_b32 v45, 2, v1
  s_mul_i32 s86, s72, 1280
  s_lshl_b32 s82, s74, 5
  s_add_u32 s87, s82, s73
  s_lshl_b32 s77, s87, 20
  s_lshl_b32 s83, s75, 19
  s_add_u32 s77, s77, s83
  s_lshl_b32 s83, s72, 12
  s_add_u32 s77, s77, s83
  s_mul_i32 s78, s72, 655360
  s_lshl_b32 s83, s73, 8
  s_add_u32 s78, s78, s83
  s_mul_i32 s21, s20, 5
  s_lshr_b32 s21, s21, 1
  s_waitcnt lgkmcnt(0)
  s_cmp_ge_u32 s72, 4
  s_cbranch_scc1 L_nox
  buffer_load_dword v192, v45, s[28:31], s86 offen offset:0 nt
  buffer_load_dword v193, v45, s[28:31], s86 offen offset:256 nt
  buffer_load_dword v194, v45, s[28:31], s86 offen offset:512 nt
  buffer_load_dword v195, v45, s[28:31], s86 offen offset:768 nt
  buffer_load_dword v196, v45, s[28:31], s86 offen offset:1024 nt
L_nox:
  s_add_u32 s82, s78, 0
  buffer_load_dwordx4 v[152:155], v9, s[40:43], s82 offen nt
  s_add_u32 s84, s89, 0
  s_and_b32 s84, s84, 15
  s_lshl_b32 s84, s84, 15
  s_add_u32 s84, s84, s77
  buffer_load_dwordx4 v[56:59], v8, s[32:35], s84 offen offset:0 nt
  s_mov_b32 s38, 134217728
  s_mov_b32 s39, 0x20000
  s_mov_b32 s46, 5242880
  s_mov_b32 s47, 0x20000
  s_mov_b32 s50, 2211840
  s_mov_b32 s51, 0x20000
  s_mov_b32 s54, 2211840
  s_mov_b32 s55, 0x20000
  s_mov_b32 s58, 2211840
  s_mov_b32 s59, 0x20000
  s_mov_b32 s62, 5120
  s_mov_b32 s63, 0x20000
  s_mov_b32 s66, 256
  s_mov_b32 s67, 0x20000
  s_mov_b32 s70, 4194304
  s_mov_b32 s71, 0x20000
  s_lshl_b32 s76, s73, 1
  s_add_u32 s76, s76, s75
  v_lshlrev_b32 v42, 4, v2
  v_mul_u32_u24 v10, 5120, v3
  v_add_u32 v10, v10, v42
  v_mul_u32_u24 v11, 1280, v3
  v_add_u32 v11, v11, v42
  v_lshrrev_b32 v43, 3, v1
  v_and_b32 v44, 7, v1
  v_lshlrev_b32 v44, 4, v44
  v_mul_u32_u24 v12, 3456, v43
  v_add_u32 v12, v12, v44
  v_add_u32 v13, 27648, v12
  v_cmp_gt_u32 vcc, 2, v43
  v_mov_b32 v45, 0x40000000
  s_nop 0
  v_cndmask_b32 v13, v45, v13, vcc
  s_lshl_b32 s83, s87, 1
  s_add_u32 s85, s83, s75
  s_lshl_b32 s12, s85, 7
  s_add_u32 s12, s12, 1310720
  s_xor_b32 s85, s85, 1
  s_lshl_b32 s11, s85, 7
  s_add_u32 s11, s11, 1310720
  s_lshl_b32 s83, s73, 7
  s_lshl_b32 s85, s72, 4
  s_add_u32 s83, s83, s85
  s_mul_i32 s79, s83, 1280
  s_lshl_b32 s83, s74, 6
  s_add_u32 s83, s83, s76
  s_mul_i32 s13, s83, 5120
  s_lshr_b32 s82, s2, 3
  s_and_b32 s17, s2, 7
  s_and_b32 s83, s2, 3
  s_lshl_b32 s83, s83, 3
  s_mov_b32 s16, 0x1f1f1f1a
  s_bitcmp1_b32 s2, 2
  s_cselect_b32 s85, 0x19181f1f, s16
  s_lshr_b32 s85, s85, s83
  s_and_b32 s85, s85, 31
  s_and_b32 s83, s82, 7
  s_lshr_b32 s88, s82, 3
  s_cmp_eq_u32 s88, 1
  s_cselect_b32 s17, s83, s17
  s_cselect_b32 s83, s85, s82
  s_sub_u32 s85, s82, 8
  s_cmp_ge_u32 s82, 16
  s_cselect_b32 s82, s85, s83
  s_mul_i32 s83, s17, 80
  s_mul_i32 s85, s72, 10
  s_add_u32 s83, s83, s85
  s_mul_i32 s81, s83, 3456
  s_lshl_b32 s83, s82, 7
  s_add_u32 s81, s81, s83
  s_and_b32 s83, s72, 3
  s_mul_i32 s83, s83, 27
  s_add_u32 s83, s83, s82
  s_lshl_b32 s83, s83, 3
  s_add_u32 s83, s83, s17
  s_lshl_b32 s14, s83, 10
  s_add_u32 s14, s14, 1376256
  s_cmp_lt_u32 s82, 27
  s_cselect_b32 s15, 1, 0
  s_cselect_b32 s81, s81, 0x20000000
  s_lshr_b32 s82, s73, 2
  s_and_b32 s83, s73, 3
  s_mul_i32 s85, s82, 3
  s_sub_u32 s88, s83, 1
  s_cmp_eq_u32 s83, 0
  s_cselect_b32 s88, 0, s88
  s_add_u32 s88, s88, s85
  s_and_b32 s85, s82, 3
  s_lshl_b32 s85, s85, 3
  s_mov_b32 s16, 0x1f1a1918
  s_bitcmp1_b32 s82, 2
  s_cselect_b32 s16, 0x1f1f1f1f, s16
  s_lshr_b32 s85, s16, s85
  s_and_b32 s85, s85, 31
  s_cmp_eq_u32 s83, 1
  s_cselect_b32 s88, s85, s88
  s_lshl_b32 s88, s88, 1
  s_add_u32 s88, s88, s75
  s_lshl_b32 s83, s88, 5
  s_lshl_b32 s85, s72, 2
  s_add_u32 s83, s83, s85
  s_mul_i32 s80, s83, 1280
  s_mul_i32 s82, s74, 27
  s_lshr_b32 s83, s88, 1
  s_add_u32 s82, s82, s83
  s_lshl_b32 s10, s82, 13
  s_and_b32 s83, s88, 1
  s_lshl_b32 s83, s83, 8
  s_add_u32 s10, s10, s83
  s_lshl_b32 s83, s72, 5
  s_add_u32 s10, s10, s83
  s_add_u32 s10, s10, 1376256
  s_mov_b32 s4, 0x00010001
  s_mov_b32 s5, 0x00010001
  v_lshlrev_b32 v42, 3, v0
  v_mov_b32 v54, 0
  v_mov_b32 v55, 0
  ds_write_b64 v42, v[54:55] offset:10240
  v_and_b32 v42, 7, v1
  v_and_b32 v43, 1, v42
  v_lshlrev_b32 v43, 4, v43
  v_mov_b32 v44, 0xffff
  v_lshlrev_b32 v44, v43, v44
  v_lshrrev_b32 v54, 1, v42
  v_cmp_eq_u32 vcc, 0, v54
  s_nop 1
  v_cndmask_b32 v4, 0, v44, vcc
  v_cmp_eq_u32 vcc, 1, v54
  s_nop 1
  v_cndmask_b32 v5, 0, v44, vcc
  v_cmp_eq_u32 vcc, 2, v54
  s_nop 1
  v_cndmask_b32 v6, 0, v44, vcc
  v_cmp_eq_u32 vcc, 3, v54
  s_nop 1
  v_cndmask_b32 v7, 0, v44, vcc
  s_xor_b32 s82, s72, 5
  s_or_b32 s82, s2, s82
  s_cmp_lg_u32 s82, 0
  s_cbranch_scc1 L_nononce
  s_or_b32 s90, s90, 1
  v_mov_b32 v48, s90
  v_mov_b32 v49, s91
  v_mov_b32 v50, 0
  v_mov_b32 v51, 0
  s_mov_b64 exec, 1
  buffer_atomic_cmpswap_x2 v[48:51], off, s[64:67], 0 offset:128 sc1
  s_mov_b64 exec, -1
L_nononce:
  s_cmp_ge_u32 s72, 4
  s_cbranch_scc1 L_noln
  s_waitcnt vmcnt(2)
  v_lshlrev_b32 v212, 16, v192
  v_and_b32 v213, 0xffff0000, v192
  v_lshlrev_b32 v214, 16, v193
  v_and_b32 v215, 0xffff0000, v193
  v_lshlrev_b32 v216, 16, v194
  v_and_b32 v217, 0xffff0000, v194
  v_lshlrev_b32 v218, 16, v195
  v_and_b32 v219, 0xffff0000, v195
  v_lshlrev_b32 v220, 16, v196
  v_and_b32 v221, 0xffff0000, v196
  v_add_f32 v42, v212, v213
  v_add_f32 v42, v42, v214
  v_add_f32 v42, v42, v215
  v_add_f32 v42, v42, v216
  v_add_f32 v42, v42, v217
  v_add_f32 v42, v42, v218
  v_add_f32 v42, v42, v219
  v_add_f32 v42, v42, v220
  v_add_f32 v42, v42, v221
  s_nop 1
  v_add_f32_dpp v42, v42, v42 row_ror:8 row_mask:0xf bank_mask:0xf
  s_nop 1
  v_add_f32_dpp v42, v42, v42 row_ror:4 row_mask:0xf bank_mask:0xf
  s_nop 1
  v_add_f32_dpp v42, v42, v42 row_ror:2 row_mask:0xf bank_mask:0xf
  s_nop 1
  v_add_f32_dpp v42, v42, v42 row_ror:1 row_mask:0xf bank_mask:0xf
  s_nop 1
  v_mov_b32 v44, v42
  s_nop 1
  v_permlane16_swap_b32 v42, v44
  s_nop 0
  v_add_f32 v42, v42, v44
  v_mov_b32 v44, v42
  s_nop 1
  v_permlane32_swap_b32 v42, v44
  s_nop 0
  v_add_f32 v42, v42, v44
  v_mul_f32 v42, 0x3acccccd, v42
  v_sub_f32 v222, v212, v42
  v_sub_f32 v223, v213, v42
  v_sub_f32 v224, v214, v42
  v_sub_f32 v225, v215, v42
  v_sub_f32 v226, v216, v42
  v_sub_f32 v227, v217, v42
  v_sub_f32 v228, v218, v42
  v_sub_f32 v229, v219, v42
  v_sub_f32 v230, v220, v42
  v_sub_f32 v231, v221, v42
  v_mul_f32 v43, v222, v222
  v_fmac_f32 v43, v223, v223
  v_fmac_f32 v43, v224, v224
  v_fmac_f32 v43, v225, v225
  v_fmac_f32 v43, v226, v226
  v_fmac_f32 v43, v227, v227
  v_fmac_f32 v43, v228, v228
  v_fmac_f32 v43, v229, v229
  v_fmac_f32 v43, v230, v230
  v_fmac_f32 v43, v231, v231
  s_nop 1
  v_add_f32_dpp v43, v43, v43 row_ror:8 row_mask:0xf bank_mask:0xf
  s_nop 1
  v_add_f32_dpp v43, v43, v43 row_ror:4 row_mask:0xf bank_mask:0xf
  s_nop 1
  v_add_f32_dpp v43, v43, v43 row_ror:2 row_mask:0xf bank_mask:0xf
  s_nop 1
  v_add_f32_dpp v43, v43, v43 row_ror:1 row_mask:0xf bank_mask:0xf
  s_nop 1
  v_mov_b32 v44, v43
  s_nop 1
  v_permlane16_swap_b32 v43, v44
  s_nop 0
  v_add_f32 v43, v43, v44
  v_mov_b32 v44, v43
  s_nop 1
  v_permlane32_swap_b32 v43, v44
  s_nop 0
  v_add_f32 v43, v43, v44
  v_mul_f32 v43, 0x3acccccd, v43
  v_cvt_pk_bf16_f32 v42, v42, v42
  v_and_b32 v42, 0xffff0000, v42
  v_cvt_pk_bf16_f32 v43, v43, v43
  v_and_b32 v43, 0xffff0000, v43
  v_add_f32 v43, 0x3727c5ac, v43
  v_cvt_pk_bf16_f32 v43, v43, v43
  v_and_b32 v43, 0xffff0000, v43
  v_sqrt_f32 v43, v43
  s_nop 0
  v_cvt_pk_bf16_f32 v43, v43, v43
  v_and_b32 v43, 0xffff0000, v43
  v_rcp_f32 v43, v43
  s_nop 0
  v_sub_f32 v222, v212, v42
  v_sub_f32 v223, v213, v42
  v_sub_f32 v224, v214, v42
  v_sub_f32 v225, v215, v42
  v_sub_f32 v226, v216, v42
  v_sub_f32 v227, v217, v42
  v_sub_f32 v228, v218, v42
  v_sub_f32 v229, v219, v42
  v_sub_f32 v230, v220, v42
  v_sub_f32 v231, v221, v42
  v_cvt_pk_bf16_f32 v222, v222, v222
  v_and_b32 v222, 0xffff0000, v222
  v_cvt_pk_bf16_f32 v223, v223, v223
  v_and_b32 v223, 0xffff0000, v223
  v_cvt_pk_bf16_f32 v224, v224, v224
  v_and_b32 v224, 0xffff0000, v224
  v_cvt_pk_bf16_f32 v225, v225, v225
  v_and_b32 v225, 0xffff0000, v225
  v_cvt_pk_bf16_f32 v226, v226, v226
  v_and_b32 v226, 0xffff0000, v226
  v_cvt_pk_bf16_f32 v227, v227, v227
  v_and_b32 v227, 0xffff0000, v227
  v_cvt_pk_bf16_f32 v228, v228, v228
  v_and_b32 v228, 0xffff0000, v228
  v_cvt_pk_bf16_f32 v229, v229, v229
  v_and_b32 v229, 0xffff0000, v229
  v_cvt_pk_bf16_f32 v230, v230, v230
  v_and_b32 v230, 0xffff0000, v230
  v_cvt_pk_bf16_f32 v231, v231, v231
  v_and_b32 v231, 0xffff0000, v231
  v_mul_f32 v222, v222, v43
  v_mul_f32 v223, v223, v43
  v_mul_f32 v224, v224, v43
  v_mul_f32 v225, v225, v43
  v_mul_f32 v226, v226, v43
  v_mul_f32 v227, v227, v43
  v_mul_f32 v228, v228, v43
  v_mul_f32 v229, v229, v43
  v_mul_f32 v230, v230, v43
  v_mul_f32 v231, v231, v43
  v_cvt_pk_bf16_f32 v222, v222, v222
  v_cvt_pk_bf16_f32 v223, v223, v223
  v_cvt_pk_bf16_f32 v224, v224, v224
  v_cvt_pk_bf16_f32 v225, v225, v225
  v_cvt_pk_bf16_f32 v226, v226, v226
  v_cvt_pk_bf16_f32 v227, v227, v227
  v_cvt_pk_bf16_f32 v228, v228, v228
  v_cvt_pk_bf16_f32 v229, v229, v229
  v_cvt_pk_bf16_f32 v230, v230, v230
  v_cvt_pk_bf16_f32 v231, v231, v231
  s_mul_i32 s82, s72, 2560
  v_lshlrev_b32 v44, 3, v1
  v_add_u32 v44, s82, v44
  ds_write_b64 v44, v[222:223] offset:0
  ds_write_b64 v44, v[224:225] offset:512
  ds_write_b64 v44, v[226:227] offset:1024
  ds_write_b64 v44, v[228:229] offset:1536
  ds_write_b64 v44, v[230:231] offset:2048
L_noln:
  buffer_load_dwordx4 v[176:179], v12, s[48:51], s81 offen nt
  buffer_load_dwordx4 v[180:183], v13, s[48:51], s81 offen nt
  buffer_load_dwordx4 v[184:187], v12, s[52:55], s81 offen nt
  buffer_load_dwordx4 v[188:191], v13, s[52:55], s81 offen nt
  s_add_u32 s82, s78, 32768
  buffer_load_dwordx4 v[156:159], v9, s[40:43], s82 offen nt
  buffer_load_dwordx4 v[60:63], v8, s[32:35], s84 offen offset:256 nt
  s_add_u32 s82, s78, 65536
  buffer_load_dwordx4 v[160:163], v9, s[40:43], s82 offen nt
  buffer_load_dwordx4 v[64:67], v8, s[32:35], s84 offen offset:512 nt
  s_cmp_lg_u32 s72, 7
  s_cbranch_scc1 L_nopoll
  buffer_load_dwordx2 v[54:55], off, s[64:67], 0 offset:128 sc1
L_nopoll:
  s_cmp_lg_u32 s72, 6
  s_cbranch_scc1 L_nowarm
  buffer_load_dword v54, off, s[68:71], s13 sc1
  buffer_load_dword v54, off, s[68:71], s14 sc1
  buffer_load_dword v54, off, s[36:39], s77 nt
  buffer_load_dword v54, off, s[44:47], s79 nt
  buffer_load_dword v54, off, s[56:59], s80 nt
L_nowarm:
  s_waitcnt lgkmcnt(0)
  s_barrier
  s_cmp_lt_u32 s72, 4
  s_cbranch_scc1 L_prio6
  s_setprio 1
L_prio6:
  s_mul_i32 s82, s74, 640
  s_mul_i32 s83, s72, 80
  s_add_u32 s82, s82, s83
  s_lshl_b32 s82, s82, 2
  v_lshl_add_u32 v42, v3, 2, s82
  ds_read_b32 v192, v42 offset:0
  ds_read_b32 v193, v42 offset:16
  ds_read_b32 v194, v42 offset:32
  ds_read_b32 v195, v42 offset:48
  ds_read_b32 v196, v42 offset:64
  ds_read_b32 v197, v42 offset:80
  ds_read_b32 v198, v42 offset:96
  ds_read_b32 v199, v42 offset:112
  ds_read_b32 v200, v42 offset:128
  ds_read_b32 v201, v42 offset:144
  ds_read_b32 v202, v42 offset:160
  ds_read_b32 v203, v42 offset:176
  ds_read_b32 v204, v42 offset:192
  ds_read_b32 v205, v42 offset:208
  ds_read_b32 v206, v42 offset:224
  ds_read_b32 v207, v42 offset:240
  ds_read_b32 v208, v42 offset:256
  ds_read_b32 v209, v42 offset:272
  ds_read_b32 v210, v42 offset:288
  ds_read_b32 v211, v42 offset:304
  s_mul_i32 s82, s17, 80
  s_mul_i32 s83, s72, 10
  s_add_u32 s82, s82, s83
  s_lshl_b32 s82, s82, 2
  v_lshrrev_b32 v43, 3, v1
  v_lshl_add_u32 v43, v43, 2, s82
  ds_read_b32 v212, v43 offset:0
  ds_read_b32 v213, v43 offset:32
  ds_read_b32 v214, v43 offset:2560
  ds_read_b32 v215, v43 offset:2592
  ds_read_b32 v216, v43 offset:5120
  ds_read_b32 v217, v43 offset:5152
  ds_read_b32 v218, v43 offset:7680
  ds_read_b32 v219, v43 offset:7712
  s_waitcnt lgkmcnt(0)
  v_and_b32 v26, v192, v4
  v_and_b32 v27, v192, v5
  v_and_b32 v28, v192, v6
  v_and_b32 v29, v192, v7
  s_waitcnt vmcnt(9)
  s_nop 1
  v_mfma_f32_16x16x32_bf16 v[22:25], v[26:29], v[152:155], 0
  s_add_u32 s82, s78, 98304
  buffer_load_dwordx4 v[164:167], v9, s[40:43], s82 offen nt
  buffer_load_dwordx4 v[68:71], v8, s[32:35], s84 offen offset:768 nt
  v_and_b32 v30, v193, v4
  v_and_b32 v31, v193, v5
  v_and_b32 v32, v193, v6
  v_and_b32 v33, v193, v7
  s_waitcnt vmcnt(5)
  s_nop 1
  v_mfma_f32_16x16x32_bf16 v[22:25], v[30:33], v[156:159], v[22:25]
  s_add_u32 s82, s78, 131072
  buffer_load_dwordx4 v[168:171], v9, s[40:43], s82 offen nt
  s_add_u32 s84, s89, 1
  s_and_b32 s84, s84, 15
  s_lshl_b32 s84, s84, 15
  s_add_u32 s84, s84, s77
  buffer_load_dwordx4 v[72:75], v8, s[32:35], s84 offen offset:0 nt
  v_and_b32 v34, v194, v4
  v_and_b32 v35, v194, v5
  v_and_b32 v36, v194, v6
  v_and_b32 v37, v194, v7
  s_waitcnt vmcnt(5)
  s_nop 1
  v_mfma_f32_16x16x32_bf16 v[22:25], v[34:37], v[160:163], v[22:25]
  s_add_u32 s82, s78, 163840
  buffer_load_dwordx4 v[172:175], v9, s[40:43], s82 offen nt
  buffer_load_dwordx4 v[76:79], v8, s[32:35], s84 offen offset:256 nt
  v_and_b32 v38, v195, v4
  v_and_b32 v39, v195, v5
  v_and_b32 v40, v195, v6
  v_and_b32 v41, v195, v7
  s_waitcnt vmcnt(5)
  s_nop 1
  v_mfma_f32_16x16x32_bf16 v[22:25], v[38:41], v[164:167], v[22:25]
  s_add_u32 s82, s78, 196608
  buffer_load_dwordx4 v[152:155], v9, s[40:43], s82 offen nt
  buffer_load_dwordx4 v[80:83], v8, s[32:35], s84 offen offset:512 nt
  v_and_b32 v26, v196, v4
  v_and_b32 v27, v196, v5
  v_and_b32 v28, v196, v6
  v_and_b32 v29, v196, v7
  s_waitcnt vmcnt(5)
  s_nop 1
  v_mfma_f32_16x16x32_bf16 v[22:25], v[26:29], v[168:171], v[22:25]
  s_add_u32 s82, s78, 229376
  buffer_load_dwordx4 v[156:159], v9, s[40:43], s82 offen nt
  buffer_load_dwordx4 v[84:87], v8, s[32:35], s84 offen offset:768 nt
  v_and_b32 v30, v197, v4
  v_and_b32 v31, v197, v5
  v_and_b32 v32, v197, v6
  v_and_b32 v33, v197, v7
  s_waitcnt vmcnt(5)
  s_nop 1
  v_mfma_f32_16x16x32_bf16 v[22:25], v[30:33], v[172:175], v[22:25]
  s_add_u32 s82, s78, 262144
  buffer_load_dwordx4 v[160:163], v9, s[40:43], s82 offen nt
  s_add_u32 s84, s89, 2
  s_and_b32 s84, s84, 15
  s_lshl_b32 s84, s84, 15
  s_add_u32 s84, s84, s77
  buffer_load_dwordx4 v[88:91], v8, s[32:35], s84 offen offset:0 nt
  v_and_b32 v34, v198, v4
  v_and_b32 v35, v198, v5
  v_and_b32 v36, v198, v6
  v_and_b32 v37, v198, v7
  s_waitcnt vmcnt(5)
  s_nop 1
  v_mfma_f32_16x16x32_bf16 v[22:25], v[34:37], v[152:155], v[22:25]
  s_add_u32 s82, s78, 294912
  buffer_load_dwordx4 v[164:167], v9, s[40:43], s82 offen nt
  buffer_load_dwordx4 v[92:95], v8, s[32:35], s84 offen offset:256 nt
  v_and_b32 v38, v199, v4
  v_and_b32 v39, v199, v5
  v_and_b32 v40, v199, v6
  v_and_b32 v41, v199, v7
  s_waitcnt vmcnt(5)
  s_nop 1
  v_mfma_f32_16x16x32_bf16 v[22:25], v[38:41], v[156:159], v[22:25]
  s_add_u32 s82, s78, 327680
  buffer_load_dwordx4 v[168:171], v9, s[40:43], s82 offen nt
  buffer_load_dwordx4 v[96:99], v8, s[32:35], s84 offen offset:512 nt
  v_and_b32 v26, v212, v4
  v_and_b32 v27, v212, v5
  v_and_b32 v28, v212, v6
  v_and_b32 v29, v212, v7
  s_nop 1
  v_mfma_f32_16x16x32_bf16 v[220:223], v[26:29], v[176:179], 0
  v_mfma_f32_16x16x32_bf16 v[224:227], v[26:29], v[184:187], 0
  v_and_b32 v30, v213, v4
  v_and_b32 v31, v213, v5
  v_and_b32 v32, v213, v6
  v_and_b32 v33, v213, v7
  s_nop 1
  v_mfma_f32_16x16x32_bf16 v[220:223], v[30:33], v[180:183], v[220:223]
  v_mfma_f32_16x16x32_bf16 v[224:227], v[30:33], v[188:191], v[224:227]
  v_and_b32 v34, v214, v4
  v_and_b32 v35, v214, v5
  v_and_b32 v36, v214, v6
  v_and_b32 v37, v214, v7
  s_nop 1
  v_mfma_f32_16x16x32_bf16 v[228:231], v[34:37], v[176:179], 0
  v_mfma_f32_16x16x32_bf16 v[232:235], v[34:37], v[184:187], 0
  v_and_b32 v38, v215, v4
  v_and_b32 v39, v215, v5
  v_and_b32 v40, v215, v6
  v_and_b32 v41, v215, v7
  s_nop 1
  v_mfma_f32_16x16x32_bf16 v[228:231], v[38:41], v[180:183], v[228:231]
  v_mfma_f32_16x16x32_bf16 v[232:235], v[38:41], v[188:191], v[232:235]
  v_and_b32 v26, v216, v4
  v_and_b32 v27, v216, v5
  v_and_b32 v28, v216, v6
  v_and_b32 v29, v216, v7
  s_nop 1
  v_mfma_f32_16x16x32_bf16 v[236:239], v[26:29], v[176:179], 0
  v_mfma_f32_16x16x32_bf16 v[240:243], v[26:29], v[184:187], 0
  v_and_b32 v30, v217, v4
  v_and_b32 v31, v217, v5
  v_and_b32 v32, v217, v6
  v_and_b32 v33, v217, v7
  s_nop 1
  v_mfma_f32_16x16x32_bf16 v[236:239], v[30:33], v[180:183], v[236:239]
  v_mfma_f32_16x16x32_bf16 v[240:243], v[30:33], v[188:191], v[240:243]
  v_and_b32 v34, v218, v4
  v_and_b32 v35, v218, v5
  v_and_b32 v36, v218, v6
  v_and_b32 v37, v218, v7
  s_nop 1
  v_mfma_f32_16x16x32_bf16 v[244:247], v[34:37], v[176:179], 0
  v_mfma_f32_16x16x32_bf16 v[248:251], v[34:37], v[184:187], 0
  v_and_b32 v38, v219, v4
  v_and_b32 v39, v219, v5
  v_and_b32 v40, v219, v6
  v_and_b32 v41, v219, v7
  s_nop 1
  v_mfma_f32_16x16x32_bf16 v[244:247], v[38:41], v[180:183], v[244:247]
  v_mfma_f32_16x16x32_bf16 v[248:251], v[38:41], v[188:191], v[248:251]
  v_and_b32 v42, 7, v1
  v_lshlrev_b32 v42, 5, v42
  v_and_b32 v43, 1, v3
  v_lshl_add_u32 v42, v43, 4, v42
  v_lshrrev_b32 v43, 1, v3
  v_lshl_add_u32 v42, v43, 11, v42
  s_lshl_b32 s83, s72, 12
  v_add_u32 v42, s83, v42
  s_nop 7
  s_mov_b32 exec_lo, 0x00ff00ff
  s_mov_b32 exec_hi, 0xff00ff00
  ds_write_b128 v42, v[220:223] offset:20480
  ds_write_b128 v42, v[224:227] offset:20736
  ds_write_b128 v42, v[228:231] offset:20992
  ds_write_b128 v42, v[232:235] offset:21248
  ds_write_b128 v42, v[236:239] offset:21504
  ds_write_b128 v42, v[240:243] offset:21760
  ds_write_b128 v42, v[244:247] offset:22016
  ds_write_b128 v42, v[248:251] offset:22272
  s_mov_b64 exec, -1
  s_cmp_lg_u32 s72, 7
  s_cbranch_scc1 L_nopoll2
  v_or_b32 v42, v54, v55
  s_nop 0
  v_readfirstlane_b32 s83, v42
  s_nop 2
  s_cmp_lg_u32 s83, 0
  s_cbranch_scc1 L_nonce_ok_2
  s_mov_b32 s16, 40000
L_nonce_spin_1:
  s_sleep 2
  buffer_load_dwordx2 v[54:55], off, s[64:67], 0 offset:128 sc1
  s_waitcnt vmcnt(0)
  s_sub_u32 s16, s16, 1
  s_cmp_eq_u32 s16, 0
  s_cbranch_scc1 L_nonce_ok_2
  v_or_b32 v42, v54, v55
  s_nop 0
  v_readfirstlane_b32 s83, v42
  s_nop 2
  s_cmp_lg_u32 s83, 0
  s_cbranch_scc0 L_nonce_spin_1
L_nonce_ok_2:
  v_mov_b32 v42, 0
  ds_write_b64 v42, v[54:55] offset:12432
L_nopoll2:
  s_waitcnt lgkmcnt(0)
  v_and_b32 v26, v200, v4
  v_and_b32 v27, v200, v5
  v_and_b32 v28, v200, v6
  v_and_b32 v29, v200, v7
  s_waitcnt vmcnt(5)
  s_nop 1
  v_mfma_f32_16x16x32_bf16 v[22:25], v[26:29], v[160:163], v[22:25]
  s_add_u32 s82, s78, 360448
  buffer_load_dwordx4 v[172:175], v9, s[40:43], s82 offen nt
  buffer_load_dwordx4 v[100:103], v8, s[32:35], s84 offen offset:768 nt
  v_and_b32 v30, v201, v4
  v_and_b32 v31, v201, v5
  v_and_b32 v32, v201, v6
  v_and_b32 v33, v201, v7
  s_waitcnt vmcnt(5)
  s_nop 1
  v_mfma_f32_16x16x32_bf16 v[22:25], v[30:33], v[164:167], v[22:25]
  s_add_u32 s82, s78, 393216
  buffer_load_dwordx4 v[152:155], v9, s[40:43], s82 offen nt
  s_add_u32 s84, s89, 3
  s_and_b32 s84, s84, 15
  s_lshl_b32 s84, s84, 15
  s_add_u32 s84, s84, s77
  buffer_load_dwordx4 v[104:107], v8, s[32:35], s84 offen offset:0 nt
  v_and_b32 v34, v202, v4
  v_and_b32 v35, v202, v5
  v_and_b32 v36, v202, v6
  v_and_b32 v37, v202, v7
  s_waitcnt vmcnt(5)
  s_nop 1
  v_mfma_f32_16x16x32_bf16 v[22:25], v[34:37], v[168:171], v[22:25]
  s_add_u32 s82, s78, 425984
  buffer_load_dwordx4 v[156:159], v9, s[40:43], s82 offen nt
  buffer_load_dwordx4 v[108:111], v8, s[32:35], s84 offen offset:256 nt
  v_and_b32 v38, v203, v4
  v_and_b32 v39, v203, v5
  v_and_b32 v40, v203, v6
  v_and_b32 v41, v203, v7
  s_waitcnt vmcnt(5)
  s_nop 1
  v_mfma_f32_16x16x32_bf16 v[22:25], v[38:41], v[172:175], v[22:25]
  s_add_u32 s82, s78, 458752
  buffer_load_dwordx4 v[160:163], v9, s[40:43], s82 offen nt
  buffer_load_dwordx4 v[112:115], v8, s[32:35], s84 offen offset:512 nt
  v_and_b32 v26, v204, v4
  v_and_b32 v27, v204, v5
  v_and_b32 v28, v204, v6
  v_and_b32 v29, v204, v7
  s_waitcnt vmcnt(5)
  s_nop 1
  v_mfma_f32_16x16x32_bf16 v[22:25], v[26:29], v[152:155], v[22:25]
  s_add_u32 s82, s78, 491520
  buffer_load_dwordx4 v[164:167], v9, s[40:43], s82 offen nt
  buffer_load_dwordx4 v[116:119], v8, s[32:35], s84 offen offset:768 nt
  v_and_b32 v30, v205, v4
  v_and_b32 v31, v205, v5
  v_and_b32 v32, v205, v6
  v_and_b32 v33, v205, v7
  s_waitcnt vmcnt(5)
  s_nop 1
  v_mfma_f32_16x16x32_bf16 v[22:25], v[30:33], v[156:159], v[22:25]
  s_add_u32 s82, s78, 524288
  buffer_load_dwordx4 v[168:171], v9, s[40:43], s82 offen nt
  s_add_u32 s84, s89, 4
  s_and_b32 s84, s84, 15
  s_lshl_b32 s84, s84, 15
  s_add_u32 s84, s84, s77
  buffer_load_dwordx4 v[120:123], v8, s[32:35], s84 offen offset:0 nt
  v_and_b32 v34, v206, v4
  v_and_b32 v35, v206, v5
  v_and_b32 v36, v206, v6
  v_and_b32 v37, v206, v7
  s_waitcnt vmcnt(5)
  s_nop 1
  v_mfma_f32_16x16x32_bf16 v[22:25], v[34:37], v[160:163], v[22:25]
  s_add_u32 s82, s78, 557056
  buffer_load_dwordx4 v[172:175], v9, s[40:43], s82 offen nt
  buffer_load_dwordx4 v[124:127], v8, s[32:35], s84 offen offset:256 nt
  v_and_b32 v38, v207, v4
  v_and_b32 v39, v207, v5
  v_and_b32 v40, v207, v6
  v_and_b32 v41, v207, v7
  s_waitcnt vmcnt(5)
  s_nop 1
  v_mfma_f32_16x16x32_bf16 v[22:25], v[38:41], v[164:167], v[22:25]
  s_add_u32 s82, s78, 589824
  buffer_load_dwordx4 v[152:155], v9, s[40:43], s82 offen nt
  buffer_load_dwordx4 v[128:131], v8, s[32:35], s84 offen offset:512 nt
  v_and_b32 v26, v208, v4
  v_and_b32 v27, v208, v5
  v_and_b32 v28, v208, v6
  v_and_b32 v29, v208, v7
  s_waitcnt vmcnt(5)
  s_nop 1
  v_mfma_f32_16x16x32_bf16 v[22:25], v[26:29], v[168:171], v[22:25]
  s_add_u32 s82, s78, 622592
  buffer_load_dwordx4 v[156:159], v9, s[40:43], s82 offen nt
  buffer_load_dwordx4 v[132:135], v8, s[32:35], s84 offen offset:768 nt
  v_and_b32 v30, v209, v4
  v_and_b32 v31, v209, v5
  v_and_b32 v32, v209, v6
  v_and_b32 v33, v209, v7
  s_waitcnt vmcnt(5)
  s_nop 1
  v_mfma_f32_16x16x32_bf16 v[22:25], v[30:33], v[172:175], v[22:25]
  s_add_u32 s84, s89, 5
  s_and_b32 s84, s84, 15
  s_lshl_b32 s84, s84, 15
  s_add_u32 s84, s84, s77
  buffer_load_dwordx4 v[136:139], v8, s[32:35], s84 offen offset:0 nt
  v_and_b32 v34, v210, v4
  v_and_b32 v35, v210, v5
  v_and_b32 v36, v210, v6
  v_and_b32 v37, v210, v7
  s_waitcnt vmcnt(4)
  s_nop 1
  v_mfma_f32_16x16x32_bf16 v[22:25], v[34:37], v[152:155], v[22:25]
  buffer_load_dwordx4 v[140:143], v8, s[32:35], s84 offen offset:256 nt
  v_and_b32 v38, v211, v4
  v_and_b32 v39, v211, v5
  v_and_b32 v40, v211, v6
  v_and_b32 v41, v211, v7
  s_waitcnt vmcnt(3)
  s_nop 1
  v_mfma_f32_16x16x32_bf16 v[22:25], v[38:41], v[156:159], v[22:25]
  buffer_load_dwordx4 v[144:147], v8, s[32:35], s84 offen offset:512 nt
  s_lshl_b32 s82, s72, 9
  v_lshlrev_b32 v43, 5, v2
  v_lshl_add_u32 v43, v3, 4, v43
  v_add_u32 v43, s82, v43
  s_nop 4
  s_mov_b32 exec_lo, -1
  s_mov_b32 exec_hi, 0
  ds_write_b128 v43, v[22:25] offset:14336
  s_mov_b64 exec, -1
  buffer_load_dwordx4 v[148:151], v8, s[32:35], s84 offen offset:768 nt
  s_waitcnt lgkmcnt(0)
  s_barrier
  v_lshlrev_b32 v45, 3, v1
  v_mov_b32 v42, 0
  ds_read_b64 v[26:27], v45 offset:14336
  ds_read_b64 v[28:29], v45 offset:14848
  ds_read_b64 v[30:31], v45 offset:15360
  ds_read_b64 v[32:33], v45 offset:15872
  ds_read_b64 v[34:35], v45 offset:16384
  ds_read_b64 v[36:37], v45 offset:16896
  ds_read_b64 v[38:39], v45 offset:17408
  ds_read_b64 v[40:41], v45 offset:17920
  ds_read_b64 v[54:55], v42 offset:12432
  s_waitcnt lgkmcnt(0)
  v_readfirstlane_b32 s90, v54
  v_readfirstlane_b32 s91, v55
  v_pk_add_f32 v[26:27], v[26:27], v[34:35]
  v_pk_add_f32 v[28:29], v[28:29], v[36:37]
  v_pk_add_f32 v[30:31], v[30:31], v[38:39]
  v_pk_add_f32 v[32:33], v[32:33], v[40:41]
  v_pk_add_f32 v[26:27], v[26:27], v[30:31]
  v_pk_add_f32 v[28:29], v[28:29], v[32:33]
  v_pk_add_f32 v[26:27], v[26:27], v[28:29]
  v_cvt_pk_bf16_f32 v26, v26, v27
  s_lshl_b32 s82, s72, 8
  v_lshl_add_u32 v42, v1, 2, s82
  ds_write_b32 v42, v26 offset:18432
  v_lshl_add_u32 v43, v2, 4, s82
  s_waitcnt lgkmcnt(0)
  ds_read_b128 v[14:17], v43 offset:18432
  s_cmp_lt_u32 s72, 4
  s_cbranch_scc1 L_nopub
  s_cmp_eq_u32 s15, 0
  s_cbranch_scc1 L_nopub
  s_and_b32 s82, s72, 3
  s_lshl_b32 s82, s82, 9
  s_add_u32 s82, s82, 20480
  v_lshl_add_u32 v44, v1, 3, s82
  ds_read_b64 v[152:153], v44 offset:0
  ds_read_b64 v[154:155], v44 offset:2048
  ds_read_b64 v[156:157], v44 offset:4096
  ds_read_b64 v[158:159], v44 offset:6144
  ds_read_b64 v[160:161], v44 offset:8192
  ds_read_b64 v[162:163], v44 offset:10240
  ds_read_b64 v[164:165], v44 offset:12288
  ds_read_b64 v[166:167], v44 offset:14336
  s_waitcnt lgkmcnt(0)
  v_pk_add_f32 v[152:153], v[152:153], v[160:161]
  v_pk_add_f32 v[154:155], v[154:155], v[162:163]
  v_pk_add_f32 v[156:157], v[156:157], v[164:165]
  v_pk_add_f32 v[158:159], v[158:159], v[166:167]
  v_pk_add_f32 v[152:153], v[152:153], v[156:157]
  v_pk_add_f32 v[154:155], v[154:155], v[158:159]
  v_pk_add_f32 v[152:153], v[152:153], v[154:155]
  v_mov_b32 v168, v152
  v_mov_b32 v169, v153
  ds_read_b64 v[152:153], v44 offset:16384
  ds_read_b64 v[154:155], v44 offset:18432
  ds_read_b64 v[156:157], v44 offset:20480
  ds_read_b64 v[158:159], v44 offset:22528
  ds_read_b64 v[160:161], v44 offset:24576
  ds_read_b64 v[162:163], v44 offset:26624
  ds_read_b64 v[164:165], v44 offset:28672
  ds_read_b64 v[166:167], v44 offset:30720
  s_waitcnt lgkmcnt(0)
  v_pk_add_f32 v[152:153], v[152:153], v[160:161]
  v_pk_add_f32 v[154:155], v[154:155], v[162:163]
  v_pk_add_f32 v[156:157], v[156:157], v[164:165]
  v_pk_add_f32 v[158:159], v[158:159], v[166:167]
  v_pk_add_f32 v[152:153], v[152:153], v[156:157]
  v_pk_add_f32 v[154:155], v[154:155], v[158:159]
  v_pk_add_f32 v[152:153], v[152:153], v[154:155]
  v_pk_add_f32 v[152:153], v[152:153], v[168:169]
  v_mov_b32 v154, v54
  v_mov_b32 v155, v55
  v_lshlrev_b32 v44, 4, v1
  buffer_store_dwordx4 v[152:155], v44, s[68:71], s14 offen sc1
L_nopub:
  s_waitcnt lgkmcnt(0)
  v_dot2_f32_bf16 v42, v56, v14, 0
  v_dot2_f32_bf16 v43, v60, v14, 0
  v_dot2_f32_bf16 v44, v64, v14, 0
  v_dot2_f32_bf16 v45, v68, v14, 0
  v_dot2_f32_bf16 v42, v57, v15, v42
  v_dot2_f32_bf16 v43, v61, v15, v43
  v_dot2_f32_bf16 v44, v65, v15, v44
  v_dot2_f32_bf16 v45, v69, v15, v45
  v_dot2_f32_bf16 v42, v58, v16, v42
  v_dot2_f32_bf16 v43, v62, v16, v43
  v_dot2_f32_bf16 v44, v66, v16, v44
  v_dot2_f32_bf16 v45, v70, v16, v45
  v_dot2_f32_bf16 v42, v59, v17, v42
  v_dot2_f32_bf16 v43, v63, v17, v43
  v_dot2_f32_bf16 v44, v67, v17, v44
  v_dot2_f32_bf16 v45, v71, v17, v45
  v_add_f32_dpp v42, v42, v42 row_ror:8 row_mask:0xf bank_mask:0xf
  v_add_f32_dpp v43, v43, v43 row_ror:8 row_mask:0xf bank_mask:0xf
  v_add_f32_dpp v44, v44, v44 row_ror:8 row_mask:0xf bank_mask:0xf
  v_add_f32_dpp v45, v45, v45 row_ror:8 row_mask:0xf bank_mask:0xf
  v_add_f32_dpp v42, v42, v42 row_ror:4 row_mask:0xf bank_mask:0xf
  v_add_f32_dpp v43, v43, v43 row_ror:4 row_mask:0xf bank_mask:0xf
  v_add_f32_dpp v44, v44, v44 row_ror:4 row_mask:0xf bank_mask:0xf
  v_add_f32_dpp v45, v45, v45 row_ror:4 row_mask:0xf bank_mask:0xf
  v_add_f32_dpp v42, v42, v42 row_ror:2 row_mask:0xf bank_mask:0xf
  v_add_f32_dpp v43, v43, v43 row_ror:2 row_mask:0xf bank_mask:0xf
  v_add_f32_dpp v44, v44, v44 row_ror:2 row_mask:0xf bank_mask:0xf
  v_add_f32_dpp v45, v45, v45 row_ror:2 row_mask:0xf bank_mask:0xf
  v_add_f32_dpp v42, v42, v42 row_ror:1 row_mask:0xf bank_mask:0xf
  v_add_f32_dpp v43, v43, v43 row_ror:1 row_mask:0xf bank_mask:0xf
  v_add_f32_dpp v44, v44, v44 row_ror:1 row_mask:0xf bank_mask:0xf
  v_add_f32_dpp v45, v45, v45 row_ror:1 row_mask:0xf bank_mask:0xf
  s_lshl_b64 s[6:7], s[4:5], 0
  v_cndmask_b32 v18, v18, v42, s[6:7]
  v_cndmask_b32 v19, v19, v43, s[6:7]
  v_cndmask_b32 v20, v20, v44, s[6:7]
  v_cndmask_b32 v21, v21, v45, s[6:7]
  v_dot2_f32_bf16 v42, v72, v14, 0
  v_dot2_f32_bf16 v43, v76, v14, 0
  v_dot2_f32_bf16 v44, v80, v14, 0
  v_dot2_f32_bf16 v45, v84, v14, 0
  v_dot2_f32_bf16 v42, v73, v15, v42
  v_dot2_f32_bf16 v43, v77, v15, v43
  v_dot2_f32_bf16 v44, v81, v15, v44
  v_dot2_f32_bf16 v45, v85, v15, v45
  v_dot2_f32_bf16 v42, v74, v16, v42
  v_dot2_f32_bf16 v43, v78, v16, v43
  v_dot2_f32_bf16 v44, v82, v16, v44
  v_dot2_f32_bf16 v45, v86, v16, v45
  v_dot2_f32_bf16 v42, v75, v17, v42
  v_dot2_f32_bf16 v43, v79, v17, v43
  v_dot2_f32_bf16 v44, v83, v17, v44
  v_dot2_f32_bf16 v45, v87, v17, v45
  v_add_f32_dpp v42, v42, v42 row_ror:8 row_mask:0xf bank_mask:0xf
  v_add_f32_dpp v43, v43, v43 row_ror:8 row_mask:0xf bank_mask:0xf
  v_add_f32_dpp v44, v44, v44 row_ror:8 row_mask:0xf bank_mask:0xf
  v_add_f32_dpp v45, v45, v45 row_ror:8 row_mask:0xf bank_mask:0xf
  v_add_f32_dpp v42, v42, v42 row_ror:4 row_mask:0xf bank_mask:0xf
  v_add_f32_dpp v43, v43, v43 row_ror:4 row_mask:0xf bank_mask:0xf
  v_add_f32_dpp v44, v44, v44 row_ror:4 row_mask:0xf bank_mask:0xf
  v_add_f32_dpp v45, v45, v45 row_ror:4 row_mask:0xf bank_mask:0xf
  v_add_f32_dpp v42, v42, v42 row_ror:2 row_mask:0xf bank_mask:0xf
  v_add_f32_dpp v43, v43, v43 row_ror:2 row_mask:0xf bank_mask:0xf
  v_add_f32_dpp v44, v44, v44 row_ror:2 row_mask:0xf bank_mask:0xf
  v_add_f32_dpp v45, v45, v45 row_ror:2 row_mask:0xf bank_mask:0xf
  v_add_f32_dpp v42, v42, v42 row_ror:1 row_mask:0xf bank_mask:0xf
  v_add_f32_dpp v43, v43, v43 row_ror:1 row_mask:0xf bank_mask:0xf
  v_add_f32_dpp v44, v44, v44 row_ror:1 row_mask:0xf bank_mask:0xf
  v_add_f32_dpp v45, v45, v45 row_ror:1 row_mask:0xf bank_mask:0xf
  s_lshl_b64 s[6:7], s[4:5], 1
  v_cndmask_b32 v18, v18, v42, s[6:7]
  v_cndmask_b32 v19, v19, v43, s[6:7]
  v_cndmask_b32 v20, v20, v44, s[6:7]
  v_cndmask_b32 v21, v21, v45, s[6:7]
  v_dot2_f32_bf16 v42, v88, v14, 0
  v_dot2_f32_bf16 v43, v92, v14, 0
  v_dot2_f32_bf16 v44, v96, v14, 0
  v_dot2_f32_bf16 v45, v100, v14, 0
  v_dot2_f32_bf16 v42, v89, v15, v42
  v_dot2_f32_bf16 v43, v93, v15, v43
  v_dot2_f32_bf16 v44, v97, v15, v44
  v_dot2_f32_bf16 v45, v101, v15, v45
  v_dot2_f32_bf16 v42, v90, v16, v42
  v_dot2_f32_bf16 v43, v94, v16, v43
  v_dot2_f32_bf16 v44, v98, v16, v44
  v_dot2_f32_bf16 v45, v102, v16, v45
  v_dot2_f32_bf16 v42, v91, v17, v42
  v_dot2_f32_bf16 v43, v95, v17, v43
  v_dot2_f32_bf16 v44, v99, v17, v44
  v_dot2_f32_bf16 v45, v103, v17, v45
  s_add_u32 s85, s79, 0
  buffer_load_dwordx4 v[152:155], v10, s[44:47], s85 offen offset:0 nt
  v_add_f32_dpp v42, v42, v42 row_ror:8 row_mask:0xf bank_mask:0xf
  v_add_f32_dpp v43, v43, v43 row_ror:8 row_mask:0xf bank_mask:0xf
  v_add_f32_dpp v44, v44, v44 row_ror:8 row_mask:0xf bank_mask:0xf
  v_add_f32_dpp v45, v45, v45 row_ror:8 row_mask:0xf bank_mask:0xf
  v_add_f32_dpp v42, v42, v42 row_ror:4 row_mask:0xf bank_mask:0xf
  v_add_f32_dpp v43, v43, v43 row_ror:4 row_mask:0xf bank_mask:0xf
  v_add_f32_dpp v44, v44, v44 row_ror:4 row_mask:0xf bank_mask:0xf
  v_add_f32_dpp v45, v45, v45 row_ror:4 row_mask:0xf bank_mask:0xf
  v_add_f32_dpp v42, v42, v42 row_ror:2 row_mask:0xf bank_mask:0xf
  v_add_f32_dpp v43, v43, v43 row_ror:2 row_mask:0xf bank_mask:0xf
  v_add_f32_dpp v44, v44, v44 row_ror:2 row_mask:0xf bank_mask:0xf
  v_add_f32_dpp v45, v45, v45 row_ror:2 row_mask:0xf bank_mask:0xf
  v_add_f32_dpp v42, v42, v42 row_ror:1 row_mask:0xf bank_mask:0xf
  v_add_f32_dpp v43, v43, v43 row_ror:1 row_mask:0xf bank_mask:0xf
  v_add_f32_dpp v44, v44, v44 row_ror:1 row_mask:0xf bank_mask:0xf
  v_add_f32_dpp v45, v45, v45 row_ror:1 row_mask:0xf bank_mask:0xf
  s_lshl_b64 s[6:7], s[4:5], 2
  v_cndmask_b32 v18, v18, v42, s[6:7]
  v_cndmask_b32 v19, v19, v43, s[6:7]
  v_cndmask_b32 v20, v20, v44, s[6:7]
  v_cndmask_b32 v21, v21, v45, s[6:7]
  v_dot2_f32_bf16 v42, v104, v14, 0
  v_dot2_f32_bf16 v43, v108, v14, 0
  v_dot2_f32_bf16 v44, v112, v14, 0
  v_dot2_f32_bf16 v45, v116, v14, 0
  v_dot2_f32_bf16 v42, v105, v15, v42
  v_dot2_f32_bf16 v43, v109, v15, v43
  v_dot2_f32_bf16 v44, v113, v15, v44
  v_dot2_f32_bf16 v45, v117, v15, v45
  v_dot2_f32_bf16 v42, v106, v16, v42
  v_dot2_f32_bf16 v43, v110, v16, v43
  v_dot2_f32_bf16 v44, v114, v16, v44
  v_dot2_f32_bf16 v45, v118, v16, v45
  v_dot2_f32_bf16 v42, v107, v17, v42
  v_dot2_f32_bf16 v43, v111, v17, v43
  v_dot2_f32_bf16 v44, v115, v17, v44
  v_dot2_f32_bf16 v45, v119, v17, v45
  buffer_load_dwordx4 v[156:159], v10, s[44:47], s85 offen offset:256 nt
  v_add_f32_dpp v42, v42, v42 row_ror:8 row_mask:0xf bank_mask:0xf
  v_add_f32_dpp v43, v43, v43 row_ror:8 row_mask:0xf bank_mask:0xf
  v_add_f32_dpp v44, v44, v44 row_ror:8 row_mask:0xf bank_mask:0xf
  v_add_f32_dpp v45, v45, v45 row_ror:8 row_mask:0xf bank_mask:0xf
  v_add_f32_dpp v42, v42, v42 row_ror:4 row_mask:0xf bank_mask:0xf
  v_add_f32_dpp v43, v43, v43 row_ror:4 row_mask:0xf bank_mask:0xf
  v_add_f32_dpp v44, v44, v44 row_ror:4 row_mask:0xf bank_mask:0xf
  v_add_f32_dpp v45, v45, v45 row_ror:4 row_mask:0xf bank_mask:0xf
  v_add_f32_dpp v42, v42, v42 row_ror:2 row_mask:0xf bank_mask:0xf
  v_add_f32_dpp v43, v43, v43 row_ror:2 row_mask:0xf bank_mask:0xf
  v_add_f32_dpp v44, v44, v44 row_ror:2 row_mask:0xf bank_mask:0xf
  v_add_f32_dpp v45, v45, v45 row_ror:2 row_mask:0xf bank_mask:0xf
  v_add_f32_dpp v42, v42, v42 row_ror:1 row_mask:0xf bank_mask:0xf
  v_add_f32_dpp v43, v43, v43 row_ror:1 row_mask:0xf bank_mask:0xf
  v_add_f32_dpp v44, v44, v44 row_ror:1 row_mask:0xf bank_mask:0xf
  v_add_f32_dpp v45, v45, v45 row_ror:1 row_mask:0xf bank_mask:0xf
  s_lshl_b64 s[6:7], s[4:5], 3
  v_cndmask_b32 v18, v18, v42, s[6:7]
  v_cndmask_b32 v19, v19, v43, s[6:7]
  v_cndmask_b32 v20, v20, v44, s[6:7]
  v_cndmask_b32 v21, v21, v45, s[6:7]
  s_waitcnt vmcnt(6)
  v_dot2_f32_bf16 v42, v120, v14, 0
  v_dot2_f32_bf16 v43, v124, v14, 0
  v_dot2_f32_bf16 v44, v128, v14, 0
  v_dot2_f32_bf16 v45, v132, v14, 0
  v_dot2_f32_bf16 v42, v121, v15, v42
  v_dot2_f32_bf16 v43, v125, v15, v43
  v_dot2_f32_bf16 v44, v129, v15, v44
  v_dot2_f32_bf16 v45, v133, v15, v45
  v_dot2_f32_bf16 v42, v122, v16, v42
  v_dot2_f32_bf16 v43, v126, v16, v43
  v_dot2_f32_bf16 v44, v130, v16, v44
  v_dot2_f32_bf16 v45, v134, v16, v45
  v_dot2_f32_bf16 v42, v123, v17, v42
  v_dot2_f32_bf16 v43, v127, v17, v43
  v_dot2_f32_bf16 v44, v131, v17, v44
  v_dot2_f32_bf16 v45, v135, v17, v45
  s_add_u32 s84, s89, 6
  s_and_b32 s84, s84, 15
  s_lshl_b32 s84, s84, 15
  s_add_u32 s84, s84, s77
  buffer_load_dwordx4 v[56:59], v8, s[32:35], s84 offen offset:0 nt
  buffer_load_dwordx4 v[160:163], v10, s[44:47], s85 offen offset:512 nt
  v_add_f32_dpp v42, v42, v42 row_ror:8 row_mask:0xf bank_mask:0xf
  v_add_f32_dpp v43, v43, v43 row_ror:8 row_mask:0xf bank_mask:0xf
  v_add_f32_dpp v44, v44, v44 row_ror:8 row_mask:0xf bank_mask:0xf
  v_add_f32_dpp v45, v45, v45 row_ror:8 row_mask:0xf bank_mask:0xf
  v_add_f32_dpp v42, v42, v42 row_ror:4 row_mask:0xf bank_mask:0xf
  v_add_f32_dpp v43, v43, v43 row_ror:4 row_mask:0xf bank_mask:0xf
  v_add_f32_dpp v44, v44, v44 row_ror:4 row_mask:0xf bank_mask:0xf
  v_add_f32_dpp v45, v45, v45 row_ror:4 row_mask:0xf bank_mask:0xf
  v_add_f32_dpp v42, v42, v42 row_ror:2 row_mask:0xf bank_mask:0xf
  v_add_f32_dpp v43, v43, v43 row_ror:2 row_mask:0xf bank_mask:0xf
  v_add_f32_dpp v44, v44, v44 row_ror:2 row_mask:0xf bank_mask:0xf
  v_add_f32_dpp v45, v45, v45 row_ror:2 row_mask:0xf bank_mask:0xf
  v_add_f32_dpp v42, v42, v42 row_ror:1 row_mask:0xf bank_mask:0xf
  v_add_f32_dpp v43, v43, v43 row_ror:1 row_mask:0xf bank_mask:0xf
  v_add_f32_dpp v44, v44, v44 row_ror:1 row_mask:0xf bank_mask:0xf
  v_add_f32_dpp v45, v45, v45 row_ror:1 row_mask:0xf bank_mask:0xf
  s_lshl_b64 s[6:7], s[4:5], 4
  v_cndmask_b32 v18, v18, v42, s[6:7]
  v_cndmask_b32 v19, v19, v43, s[6:7]
  v_cndmask_b32 v20, v20, v44, s[6:7]
  v_cndmask_b32 v21, v21, v45, s[6:7]
  s_waitcnt vmcnt(4)
  v_dot2_f32_bf16 v42, v136, v14, 0
  v_dot2_f32_bf16 v43, v140, v14, 0
  v_dot2_f32_bf16 v44, v144, v14, 0
  v_dot2_f32_bf16 v45, v148, v14, 0
  v_dot2_f32_bf16 v42, v137, v15, v42
  v_dot2_f32_bf16 v43, v141, v15, v43
  v_dot2_f32_bf16 v44, v145, v15, v44
  v_dot2_f32_bf16 v45, v149, v15, v45
  v_dot2_f32_bf16 v42, v138, v16, v42
  v_dot2_f32_bf16 v43, v142, v16, v43
  v_dot2_f32_bf16 v44, v146, v16, v44
  v_dot2_f32_bf16 v45, v150, v16, v45
  v_dot2_f32_bf16 v42, v139, v17, v42
  v_dot2_f32_bf16 v43, v143, v17, v43
  v_dot2_f32_bf16 v44, v147, v17, v44
  v_dot2_f32_bf16 v45, v151, v17, v45
  buffer_load_dwordx4 v[60:63], v8, s[32:35], s84 offen offset:256 nt
  buffer_load_dwordx4 v[64:67], v8, s[32:35], s84 offen offset:512 nt
  buffer_load_dwordx4 v[68:71], v8, s[32:35], s84 offen offset:768 nt
  s_add_u32 s84, s89, 7
  s_and_b32 s84, s84, 15
  s_lshl_b32 s84, s84, 15
  s_add_u32 s84, s84, s77
  buffer_load_dwordx4 v[72:75], v8, s[32:35], s84 offen offset:0 nt
  buffer_load_dwordx4 v[164:167], v10, s[44:47], s85 offen offset:768 nt
  v_add_f32_dpp v42, v42, v42 row_ror:8 row_mask:0xf bank_mask:0xf
  v_add_f32_dpp v43, v43, v43 row_ror:8 row_mask:0xf bank_mask:0xf
  v_add_f32_dpp v44, v44, v44 row_ror:8 row_mask:0xf bank_mask:0xf
  v_add_f32_dpp v45, v45, v45 row_ror:8 row_mask:0xf bank_mask:0xf
  v_add_f32_dpp v42, v42, v42 row_ror:4 row_mask:0xf bank_mask:0xf
  v_add_f32_dpp v43, v43, v43 row_ror:4 row_mask:0xf bank_mask:0xf
  v_add_f32_dpp v44, v44, v44 row_ror:4 row_mask:0xf bank_mask:0xf
  v_add_f32_dpp v45, v45, v45 row_ror:4 row_mask:0xf bank_mask:0xf
  v_add_f32_dpp v42, v42, v42 row_ror:2 row_mask:0xf bank_mask:0xf
  v_add_f32_dpp v43, v43, v43 row_ror:2 row_mask:0xf bank_mask:0xf
  v_add_f32_dpp v44, v44, v44 row_ror:2 row_mask:0xf bank_mask:0xf
  v_add_f32_dpp v45, v45, v45 row_ror:2 row_mask:0xf bank_mask:0xf
  v_add_f32_dpp v42, v42, v42 row_ror:1 row_mask:0xf bank_mask:0xf
  v_add_f32_dpp v43, v43, v43 row_ror:1 row_mask:0xf bank_mask:0xf
  v_add_f32_dpp v44, v44, v44 row_ror:1 row_mask:0xf bank_mask:0xf
  v_add_f32_dpp v45, v45, v45 row_ror:1 row_mask:0xf bank_mask:0xf
  s_lshl_b64 s[6:7], s[4:5], 5
  v_cndmask_b32 v18, v18, v42, s[6:7]
  v_cndmask_b32 v19, v19, v43, s[6:7]
  v_cndmask_b32 v20, v20, v44, s[6:7]
  v_cndmask_b32 v21, v21, v45, s[6:7]
  s_waitcnt vmcnt(2)
  v_dot2_f32_bf16 v42, v56, v14, 0
  v_dot2_f32_bf16 v43, v60, v14, 0
  v_dot2_f32_bf16 v44, v64, v14, 0
  v_dot2_f32_bf16 v45, v68, v14, 0
  v_dot2_f32_bf16 v42, v57, v15, v42
  v_dot2_f32_bf16 v43, v61, v15, v43
  v_dot2_f32_bf16 v44, v65, v15, v44
  v_dot2_f32_bf16 v45, v69, v15, v45
  v_dot2_f32_bf16 v42, v58, v16, v42
  v_dot2_f32_bf16 v43, v62, v16, v43
  v_dot2_f32_bf16 v44, v66, v16, v44
  v_dot2_f32_bf16 v45, v70, v16, v45
  v_dot2_f32_bf16 v42, v59, v17, v42
  v_dot2_f32_bf16 v43, v63, v17, v43
  v_dot2_f32_bf16 v44, v67, v17, v44
  v_dot2_f32_bf16 v45, v71, v17, v45
  buffer_load_dwordx4 v[76:79], v8, s[32:35], s84 offen offset:256 nt
  buffer_load_dwordx4 v[80:83], v8, s[32:35], s84 offen offset:512 nt
  buffer_load_dwordx4 v[84:87], v8, s[32:35], s84 offen offset:768 nt
  s_add_u32 s84, s89, 8
  s_and_b32 s84, s84, 15
  s_lshl_b32 s84, s84, 15
  s_add_u32 s84, s84, s77
  buffer_load_dwordx4 v[88:91], v8, s[32:35], s84 offen offset:0 nt
  buffer_load_dwordx4 v[168:171], v10, s[44:47], s85 offen offset:1024 nt
  v_add_f32_dpp v42, v42, v42 row_ror:8 row_mask:0xf bank_mask:0xf
  v_add_f32_dpp v43, v43, v43 row_ror:8 row_mask:0xf bank_mask:0xf
  v_add_f32_dpp v44, v44, v44 row_ror:8 row_mask:0xf bank_mask:0xf
  v_add_f32_dpp v45, v45, v45 row_ror:8 row_mask:0xf bank_mask:0xf
  v_add_f32_dpp v42, v42, v42 row_ror:4 row_mask:0xf bank_mask:0xf
  v_add_f32_dpp v43, v43, v43 row_ror:4 row_mask:0xf bank_mask:0xf
  v_add_f32_dpp v44, v44, v44 row_ror:4 row_mask:0xf bank_mask:0xf
  v_add_f32_dpp v45, v45, v45 row_ror:4 row_mask:0xf bank_mask:0xf
  v_add_f32_dpp v42, v42, v42 row_ror:2 row_mask:0xf bank_mask:0xf
  v_add_f32_dpp v43, v43, v43 row_ror:2 row_mask:0xf bank_mask:0xf
  v_add_f32_dpp v44, v44, v44 row_ror:2 row_mask:0xf bank_mask:0xf
  v_add_f32_dpp v45, v45, v45 row_ror:2 row_mask:0xf bank_mask:0xf
  v_add_f32_dpp v42, v42, v42 row_ror:1 row_mask:0xf bank_mask:0xf
  v_add_f32_dpp v43, v43, v43 row_ror:1 row_mask:0xf bank_mask:0xf
  v_add_f32_dpp v44, v44, v44 row_ror:1 row_mask:0xf bank_mask:0xf
  v_add_f32_dpp v45, v45, v45 row_ror:1 row_mask:0xf bank_mask:0xf
  s_lshl_b64 s[6:7], s[4:5], 6
  v_cndmask_b32 v18, v18, v42, s[6:7]
  v_cndmask_b32 v19, v19, v43, s[6:7]
  v_cndmask_b32 v20, v20, v44, s[6:7]
  v_cndmask_b32 v21, v21, v45, s[6:7]
  s_waitcnt vmcnt(2)
  v_dot2_f32_bf16 v42, v72, v14, 0
  v_dot2_f32_bf16 v43, v76, v14, 0
  v_dot2_f32_bf16 v44, v80, v14, 0
  v_dot2_f32_bf16 v45, v84, v14, 0
  v_dot2_f32_bf16 v42, v73, v15, v42
  v_dot2_f32_bf16 v43, v77, v15, v43
  v_dot2_f32_bf16 v44, v81, v15, v44
  v_dot2_f32_bf16 v45, v85, v15, v45
  v_dot2_f32_bf16 v42, v74, v16, v42
  v_dot2_f32_bf16 v43, v78, v16, v43
  v_dot2_f32_bf16 v44, v82, v16, v44
  v_dot2_f32_bf16 v45, v86, v16, v45
  v_dot2_f32_bf16 v42, v75, v17, v42
  v_dot2_f32_bf16 v43, v79, v17, v43
  v_dot2_f32_bf16 v44, v83, v17, v44
  v_dot2_f32_bf16 v45, v87, v17, v45
  buffer_load_dwordx4 v[92:95], v8, s[32:35], s84 offen offset:256 nt
  buffer_load_dwordx4 v[96:99], v8, s[32:35], s84 offen offset:512 nt
  buffer_load_dwordx4 v[100:103], v8, s[32:35], s84 offen offset:768 nt
  s_add_u32 s84, s89, 9
  s_and_b32 s84, s84, 15
  s_lshl_b32 s84, s84, 15
  s_add_u32 s84, s84, s77
  buffer_load_dwordx4 v[104:107], v8, s[32:35], s84 offen offset:0 nt
  s_add_u32 s85, s79, 1280
  buffer_load_dwordx4 v[172:175], v10, s[44:47], s85 offen offset:0 nt
  v_add_f32_dpp v42, v42, v42 row_ror:8 row_mask:0xf bank_mask:0xf
  v_add_f32_dpp v43, v43, v43 row_ror:8 row_mask:0xf bank_mask:0xf
  v_add_f32_dpp v44, v44, v44 row_ror:8 row_mask:0xf bank_mask:0xf
  v_add_f32_dpp v45, v45, v45 row_ror:8 row_mask:0xf bank_mask:0xf
  v_add_f32_dpp v42, v42, v42 row_ror:4 row_mask:0xf bank_mask:0xf
  v_add_f32_dpp v43, v43, v43 row_ror:4 row_mask:0xf bank_mask:0xf
  v_add_f32_dpp v44, v44, v44 row_ror:4 row_mask:0xf bank_mask:0xf
  v_add_f32_dpp v45, v45, v45 row_ror:4 row_mask:0xf bank_mask:0xf
  v_add_f32_dpp v42, v42, v42 row_ror:2 row_mask:0xf bank_mask:0xf
  v_add_f32_dpp v43, v43, v43 row_ror:2 row_mask:0xf bank_mask:0xf
  v_add_f32_dpp v44, v44, v44 row_ror:2 row_mask:0xf bank_mask:0xf
  v_add_f32_dpp v45, v45, v45 row_ror:2 row_mask:0xf bank_mask:0xf
  v_add_f32_dpp v42, v42, v42 row_ror:1 row_mask:0xf bank_mask:0xf
  v_add_f32_dpp v43, v43, v43 row_ror:1 row_mask:0xf bank_mask:0xf
  v_add_f32_dpp v44, v44, v44 row_ror:1 row_mask:0xf bank_mask:0xf
  v_add_f32_dpp v45, v45, v45 row_ror:1 row_mask:0xf bank_mask:0xf
  s_lshl_b64 s[6:7], s[4:5], 7
  v_cndmask_b32 v18, v18, v42, s[6:7]
  v_cndmask_b32 v19, v19, v43, s[6:7]
  v_cndmask_b32 v20, v20, v44, s[6:7]
  v_cndmask_b32 v21, v21, v45, s[6:7]
  s_waitcnt vmcnt(2)
  v_dot2_f32_bf16 v42, v88, v14, 0
  v_dot2_f32_bf16 v43, v92, v14, 0
  v_dot2_f32_bf16 v44, v96, v14, 0
  v_dot2_f32_bf16 v45, v100, v14, 0
  v_dot2_f32_bf16 v42, v89, v15, v42
  v_dot2_f32_bf16 v43, v93, v15, v43
  v_dot2_f32_bf16 v44, v97, v15, v44
  v_dot2_f32_bf16 v45, v101, v15, v45
  v_dot2_f32_bf16 v42, v90, v16, v42
  v_dot2_f32_bf16 v43, v94, v16, v43
  v_dot2_f32_bf16 v44, v98, v16, v44
  v_dot2_f32_bf16 v45, v102, v16, v45
  v_dot2_f32_bf16 v42, v91, v17, v42
  v_dot2_f32_bf16 v43, v95, v17, v43
  v_dot2_f32_bf16 v44, v99, v17, v44
  v_dot2_f32_bf16 v45, v103, v17, v45
  buffer_load_dwordx4 v[108:111], v8, s[32:35], s84 offen offset:256 nt
  buffer_load_dwordx4 v[112:115], v8, s[32:35], s84 offen offset:512 nt
  buffer_load_dwordx4 v[116:119], v8, s[32:35], s84 offen offset:768 nt
  s_add_u32 s84, s89, 10
  s_and_b32 s84, s84, 15
  s_lshl_b32 s84, s84, 15
  s_add_u32 s84, s84, s77
  buffer_load_dwordx4 v[120:123], v8, s[32:35], s84 offen offset:0 nt
  buffer_load_dwordx4 v[176:179], v10, s[44:47], s85 offen offset:256 nt
  v_add_f32_dpp v42, v42, v42 row_ror:8 row_mask:0xf bank_mask:0xf
  v_add_f32_dpp v43, v43, v43 row_ror:8 row_mask:0xf bank_mask:0xf
  v_add_f32_dpp v44, v44, v44 row_ror:8 row_mask:0xf bank_mask:0xf
  v_add_f32_dpp v45, v45, v45 row_ror:8 row_mask:0xf bank_mask:0xf
  v_add_f32_dpp v42, v42, v42 row_ror:4 row_mask:0xf bank_mask:0xf
  v_add_f32_dpp v43, v43, v43 row_ror:4 row_mask:0xf bank_mask:0xf
  v_add_f32_dpp v44, v44, v44 row_ror:4 row_mask:0xf bank_mask:0xf
  v_add_f32_dpp v45, v45, v45 row_ror:4 row_mask:0xf bank_mask:0xf
  v_add_f32_dpp v42, v42, v42 row_ror:2 row_mask:0xf bank_mask:0xf
  v_add_f32_dpp v43, v43, v43 row_ror:2 row_mask:0xf bank_mask:0xf
  v_add_f32_dpp v44, v44, v44 row_ror:2 row_mask:0xf bank_mask:0xf
  v_add_f32_dpp v45, v45, v45 row_ror:2 row_mask:0xf bank_mask:0xf
  v_add_f32_dpp v42, v42, v42 row_ror:1 row_mask:0xf bank_mask:0xf
  v_add_f32_dpp v43, v43, v43 row_ror:1 row_mask:0xf bank_mask:0xf
  v_add_f32_dpp v44, v44, v44 row_ror:1 row_mask:0xf bank_mask:0xf
  v_add_f32_dpp v45, v45, v45 row_ror:1 row_mask:0xf bank_mask:0xf
  s_lshl_b64 s[6:7], s[4:5], 8
  v_cndmask_b32 v18, v18, v42, s[6:7]
  v_cndmask_b32 v19, v19, v43, s[6:7]
  v_cndmask_b32 v20, v20, v44, s[6:7]
  v_cndmask_b32 v21, v21, v45, s[6:7]
  s_waitcnt vmcnt(2)
  v_dot2_f32_bf16 v42, v104, v14, 0
  v_dot2_f32_bf16 v43, v108, v14, 0
  v_dot2_f32_bf16 v44, v112, v14, 0
  v_dot2_f32_bf16 v45, v116, v14, 0
  v_dot2_f32_bf16 v42, v105, v15, v42
  v_dot2_f32_bf16 v43, v109, v15, v43
  v_dot2_f32_bf16 v44, v113, v15, v44
  v_dot2_f32_bf16 v45, v117, v15, v45
  v_dot2_f32_bf16 v42, v106, v16, v42
  v_dot2_f32_bf16 v43, v110, v16, v43
  v_dot2_f32_bf16 v44, v114, v16, v44
  v_dot2_f32_bf16 v45, v118, v16, v45
  v_dot2_f32_bf16 v42, v107, v17, v42
  v_dot2_f32_bf16 v43, v111, v17, v43
  v_dot2_f32_bf16 v44, v115, v17, v44
  v_dot2_f32_bf16 v45, v119, v17, v45
  buffer_load_dwordx4 v[124:127], v8, s[32:35], s84 offen offset:256 nt
  buffer_load_dwordx4 v[128:131], v8, s[32:35], s84 offen offset:512 nt
  buffer_load_dwordx4 v[132:135], v8, s[32:35], s84 offen offset:768 nt
  s_add_u32 s84, s89, 11
  s_and_b32 s84, s84, 15
  s_lshl_b32 s84, s84, 15
  s_add_u32 s84, s84, s77
  buffer_load_dwordx4 v[136:139], v8, s[32:35], s84 offen offset:0 nt
  buffer_load_dwordx4 v[180:183], v10, s[44:47], s85 offen offset:512 nt
  v_add_f32_dpp v42, v42, v42 row_ror:8 row_mask:0xf bank_mask:0xf
  v_add_f32_dpp v43, v43, v43 row_ror:8 row_mask:0xf bank_mask:0xf
  v_add_f32_dpp v44, v44, v44 row_ror:8 row_mask:0xf bank_mask:0xf
  v_add_f32_dpp v45, v45, v45 row_ror:8 row_mask:0xf bank_mask:0xf
  v_add_f32_dpp v42, v42, v42 row_ror:4 row_mask:0xf bank_mask:0xf
  v_add_f32_dpp v43, v43, v43 row_ror:4 row_mask:0xf bank_mask:0xf
  v_add_f32_dpp v44, v44, v44 row_ror:4 row_mask:0xf bank_mask:0xf
  v_add_f32_dpp v45, v45, v45 row_ror:4 row_mask:0xf bank_mask:0xf
  v_add_f32_dpp v42, v42, v42 row_ror:2 row_mask:0xf bank_mask:0xf
  v_add_f32_dpp v43, v43, v43 row_ror:2 row_mask:0xf bank_mask:0xf
  v_add_f32_dpp v44, v44, v44 row_ror:2 row_mask:0xf bank_mask:0xf
  v_add_f32_dpp v45, v45, v45 row_ror:2 row_mask:0xf bank_mask:0xf
  v_add_f32_dpp v42, v42, v42 row_ror:1 row_mask:0xf bank_mask:0xf
  v_add_f32_dpp v43, v43, v43 row_ror:1 row_mask:0xf bank_mask:0xf
  v_add_f32_dpp v44, v44, v44 row_ror:1 row_mask:0xf bank_mask:0xf
  v_add_f32_dpp v45, v45, v45 row_ror:1 row_mask:0xf bank_mask:0xf
  s_lshl_b64 s[6:7], s[4:5], 9
  v_cndmask_b32 v18, v18, v42, s[6:7]
  v_cndmask_b32 v19, v19, v43, s[6:7]
  v_cndmask_b32 v20, v20, v44, s[6:7]
  v_cndmask_b32 v21, v21, v45, s[6:7]
  s_waitcnt vmcnt(2)
  v_dot2_f32_bf16 v42, v120, v14, 0
  v_dot2_f32_bf16 v43, v124, v14, 0
  v_dot2_f32_bf16 v44, v128, v14, 0
  v_dot2_f32_bf16 v45, v132, v14, 0
  v_dot2_f32_bf16 v42, v121, v15, v42
  v_dot2_f32_bf16 v43, v125, v15, v43
  v_dot2_f32_bf16 v44, v129, v15, v44
  v_dot2_f32_bf16 v45, v133, v15, v45
  v_dot2_f32_bf16 v42, v122, v16, v42
  v_dot2_f32_bf16 v43, v126, v16, v43
  v_dot2_f32_bf16 v44, v130, v16, v44
  v_dot2_f32_bf16 v45, v134, v16, v45
  v_dot2_f32_bf16 v42, v123, v17, v42
  v_dot2_f32_bf16 v43, v127, v17, v43
  v_dot2_f32_bf16 v44, v131, v17, v44
  v_dot2_f32_bf16 v45, v135, v17, v45
  buffer_load_dwordx4 v[140:143], v8, s[32:35], s84 offen offset:256 nt
  buffer_load_dwordx4 v[144:147], v8, s[32:35], s84 offen offset:512 nt
  buffer_load_dwordx4 v[148:151], v8, s[32:35], s84 offen offset:768 nt
  s_add_u32 s84, s89, 12
  s_and_b32 s84, s84, 15
  s_lshl_b32 s84, s84, 15
  s_add_u32 s84, s84, s77
  buffer_load_dwordx4 v[56:59], v8, s[32:35], s84 offen offset:0 nt
  buffer_load_dwordx4 v[184:187], v10, s[44:47], s85 offen offset:768 nt
  v_add_f32_dpp v42, v42, v42 row_ror:8 row_mask:0xf bank_mask:0xf
  v_add_f32_dpp v43, v43, v43 row_ror:8 row_mask:0xf bank_mask:0xf
  v_add_f32_dpp v44, v44, v44 row_ror:8 row_mask:0xf bank_mask:0xf
  v_add_f32_dpp v45, v45, v45 row_ror:8 row_mask:0xf bank_mask:0xf
  v_add_f32_dpp v42, v42, v42 row_ror:4 row_mask:0xf bank_mask:0xf
  v_add_f32_dpp v43, v43, v43 row_ror:4 row_mask:0xf bank_mask:0xf
  v_add_f32_dpp v44, v44, v44 row_ror:4 row_mask:0xf bank_mask:0xf
  v_add_f32_dpp v45, v45, v45 row_ror:4 row_mask:0xf bank_mask:0xf
  v_add_f32_dpp v42, v42, v42 row_ror:2 row_mask:0xf bank_mask:0xf
  v_add_f32_dpp v43, v43, v43 row_ror:2 row_mask:0xf bank_mask:0xf
  v_add_f32_dpp v44, v44, v44 row_ror:2 row_mask:0xf bank_mask:0xf
  v_add_f32_dpp v45, v45, v45 row_ror:2 row_mask:0xf bank_mask:0xf
  v_add_f32_dpp v42, v42, v42 row_ror:1 row_mask:0xf bank_mask:0xf
  v_add_f32_dpp v43, v43, v43 row_ror:1 row_mask:0xf bank_mask:0xf
  v_add_f32_dpp v44, v44, v44 row_ror:1 row_mask:0xf bank_mask:0xf
  v_add_f32_dpp v45, v45, v45 row_ror:1 row_mask:0xf bank_mask:0xf
  s_lshl_b64 s[6:7], s[4:5], 10
  v_cndmask_b32 v18, v18, v42, s[6:7]
  v_cndmask_b32 v19, v19, v43, s[6:7]
  v_cndmask_b32 v20, v20, v44, s[6:7]
  v_cndmask_b32 v21, v21, v45, s[6:7]
  s_waitcnt vmcnt(2)
  v_dot2_f32_bf16 v42, v136, v14, 0
  v_dot2_f32_bf16 v43, v140, v14, 0
  v_dot2_f32_bf16 v44, v144, v14, 0
  v_dot2_f32_bf16 v45, v148, v14, 0
  v_dot2_f32_bf16 v42, v137, v15, v42
  v_dot2_f32_bf16 v43, v141, v15, v43
  v_dot2_f32_bf16 v44, v145, v15, v44
  v_dot2_f32_bf16 v45, v149, v15, v45
  v_dot2_f32_bf16 v42, v138, v16, v42
  v_dot2_f32_bf16 v43, v142, v16, v43
  v_dot2_f32_bf16 v44, v146, v16, v44
  v_dot2_f32_bf16 v45, v150, v16, v45
  v_dot2_f32_bf16 v42, v139, v17, v42
  v_dot2_f32_bf16 v43, v143, v17, v43
  v_dot2_f32_bf16 v44, v147, v17, v44
  v_dot2_f32_bf16 v45, v151, v17, v45
  buffer_load_dwordx4 v[60:63], v8, s[32:35], s84 offen offset:256 nt
  buffer_load_dwordx4 v[64:67], v8, s[32:35], s84 offen offset:512 nt
  buffer_load_dwordx4 v[68:71], v8, s[32:35], s84 offen offset:768 nt
  s_add_u32 s84, s89, 13
  s_and_b32 s84, s84, 15
  s_lshl_b32 s84, s84, 15
  s_add_u32 s84, s84, s77
  buffer_load_dwordx4 v[72:75], v8, s[32:35], s84 offen offset:0 nt
  buffer_load_dwordx4 v[188:191], v10, s[44:47], s85 offen offset:1024 nt
  v_add_f32_dpp v42, v42, v42 row_ror:8 row_mask:0xf bank_mask:0xf
  v_add_f32_dpp v43, v43, v43 row_ror:8 row_mask:0xf bank_mask:0xf
  v_add_f32_dpp v44, v44, v44 row_ror:8 row_mask:0xf bank_mask:0xf
  v_add_f32_dpp v45, v45, v45 row_ror:8 row_mask:0xf bank_mask:0xf
  v_add_f32_dpp v42, v42, v42 row_ror:4 row_mask:0xf bank_mask:0xf
  v_add_f32_dpp v43, v43, v43 row_ror:4 row_mask:0xf bank_mask:0xf
  v_add_f32_dpp v44, v44, v44 row_ror:4 row_mask:0xf bank_mask:0xf
  v_add_f32_dpp v45, v45, v45 row_ror:4 row_mask:0xf bank_mask:0xf
  v_add_f32_dpp v42, v42, v42 row_ror:2 row_mask:0xf bank_mask:0xf
  v_add_f32_dpp v43, v43, v43 row_ror:2 row_mask:0xf bank_mask:0xf
  v_add_f32_dpp v44, v44, v44 row_ror:2 row_mask:0xf bank_mask:0xf
  v_add_f32_dpp v45, v45, v45 row_ror:2 row_mask:0xf bank_mask:0xf
  v_add_f32_dpp v42, v42, v42 row_ror:1 row_mask:0xf bank_mask:0xf
  v_add_f32_dpp v43, v43, v43 row_ror:1 row_mask:0xf bank_mask:0xf
  v_add_f32_dpp v44, v44, v44 row_ror:1 row_mask:0xf bank_mask:0xf
  v_add_f32_dpp v45, v45, v45 row_ror:1 row_mask:0xf bank_mask:0xf
  s_lshl_b64 s[6:7], s[4:5], 11
  v_cndmask_b32 v18, v18, v42, s[6:7]
  v_cndmask_b32 v19, v19, v43, s[6:7]
  v_cndmask_b32 v20, v20, v44, s[6:7]
  v_cndmask_b32 v21, v21, v45, s[6:7]
  s_waitcnt vmcnt(2)
  v_dot2_f32_bf16 v42, v56, v14, 0
  v_dot2_f32_bf16 v43, v60, v14, 0
  v_dot2_f32_bf16 v44, v64, v14, 0
  v_dot2_f32_bf16 v45, v68, v14, 0
  v_dot2_f32_bf16 v42, v57, v15, v42
  v_dot2_f32_bf16 v43, v61, v15, v43
  v_dot2_f32_bf16 v44, v65, v15, v44
  v_dot2_f32_bf16 v45, v69, v15, v45
  v_dot2_f32_bf16 v42, v58, v16, v42
  v_dot2_f32_bf16 v43, v62, v16, v43
  v_dot2_f32_bf16 v44, v66, v16, v44
  v_dot2_f32_bf16 v45, v70, v16, v45
  v_dot2_f32_bf16 v42, v59, v17, v42
  v_dot2_f32_bf16 v43, v63, v17, v43
  v_dot2_f32_bf16 v44, v67, v17, v44
  v_dot2_f32_bf16 v45, v71, v17, v45
  buffer_load_dwordx4 v[76:79], v8, s[32:35], s84 offen offset:256 nt
  buffer_load_dwordx4 v[80:83], v8, s[32:35], s84 offen offset:512 nt
  buffer_load_dwordx4 v[84:87], v8, s[32:35], s84 offen offset:768 nt
  s_add_u32 s84, s89, 14
  s_and_b32 s84, s84, 15
  s_lshl_b32 s84, s84, 15
  s_add_u32 s84, s84, s77
  buffer_load_dwordx4 v[88:91], v8, s[32:35], s84 offen offset:0 nt
  s_add_u32 s85, s79, 2560
  buffer_load_dwordx4 v[192:195], v10, s[44:47], s85 offen offset:0 nt
  v_add_f32_dpp v42, v42, v42 row_ror:8 row_mask:0xf bank_mask:0xf
  v_add_f32_dpp v43, v43, v43 row_ror:8 row_mask:0xf bank_mask:0xf
  v_add_f32_dpp v44, v44, v44 row_ror:8 row_mask:0xf bank_mask:0xf
  v_add_f32_dpp v45, v45, v45 row_ror:8 row_mask:0xf bank_mask:0xf
  v_add_f32_dpp v42, v42, v42 row_ror:4 row_mask:0xf bank_mask:0xf
  v_add_f32_dpp v43, v43, v43 row_ror:4 row_mask:0xf bank_mask:0xf
  v_add_f32_dpp v44, v44, v44 row_ror:4 row_mask:0xf bank_mask:0xf
  v_add_f32_dpp v45, v45, v45 row_ror:4 row_mask:0xf bank_mask:0xf
  v_add_f32_dpp v42, v42, v42 row_ror:2 row_mask:0xf bank_mask:0xf
  v_add_f32_dpp v43, v43, v43 row_ror:2 row_mask:0xf bank_mask:0xf
  v_add_f32_dpp v44, v44, v44 row_ror:2 row_mask:0xf bank_mask:0xf
  v_add_f32_dpp v45, v45, v45 row_ror:2 row_mask:0xf bank_mask:0xf
  v_add_f32_dpp v42, v42, v42 row_ror:1 row_mask:0xf bank_mask:0xf
  v_add_f32_dpp v43, v43, v43 row_ror:1 row_mask:0xf bank_mask:0xf
  v_add_f32_dpp v44, v44, v44 row_ror:1 row_mask:0xf bank_mask:0xf
  v_add_f32_dpp v45, v45, v45 row_ror:1 row_mask:0xf bank_mask:0xf
  s_lshl_b64 s[6:7], s[4:5], 12
  v_cndmask_b32 v18, v18, v42, s[6:7]
  v_cndmask_b32 v19, v19, v43, s[6:7]
  v_cndmask_b32 v20, v20, v44, s[6:7]
  v_cndmask_b32 v21, v21, v45, s[6:7]
  s_waitcnt vmcnt(2)
  v_dot2_f32_bf16 v42, v72, v14, 0
  v_dot2_f32_bf16 v43, v76, v14, 0
  v_dot2_f32_bf16 v44, v80, v14, 0
  v_dot2_f32_bf16 v45, v84, v14, 0
  v_dot2_f32_bf16 v42, v73, v15, v42
  v_dot2_f32_bf16 v43, v77, v15, v43
  v_dot2_f32_bf16 v44, v81, v15, v44
  v_dot2_f32_bf16 v45, v85, v15, v45
  v_dot2_f32_bf16 v42, v74, v16, v42
  v_dot2_f32_bf16 v43, v78, v16, v43
  v_dot2_f32_bf16 v44, v82, v16, v44
  v_dot2_f32_bf16 v45, v86, v16, v45
  v_dot2_f32_bf16 v42, v75, v17, v42
  v_dot2_f32_bf16 v43, v79, v17, v43
  v_dot2_f32_bf16 v44, v83, v17, v44
  v_dot2_f32_bf16 v45, v87, v17, v45
  buffer_load_dwordx4 v[92:95], v8, s[32:35], s84 offen offset:256 nt
  buffer_load_dwordx4 v[96:99], v8, s[32:35], s84 offen offset:512 nt
  buffer_load_dwordx4 v[100:103], v8, s[32:35], s84 offen offset:768 nt
  s_add_u32 s84, s89, 15
  s_and_b32 s84, s84, 15
  s_lshl_b32 s84, s84, 15
  s_add_u32 s84, s84, s77
  buffer_load_dwordx4 v[104:107], v8, s[32:35], s84 offen offset:0 nt
  buffer_load_dwordx4 v[196:199], v10, s[44:47], s85 offen offset:256 nt
  v_add_f32_dpp v42, v42, v42 row_ror:8 row_mask:0xf bank_mask:0xf
  v_add_f32_dpp v43, v43, v43 row_ror:8 row_mask:0xf bank_mask:0xf
  v_add_f32_dpp v44, v44, v44 row_ror:8 row_mask:0xf bank_mask:0xf
  v_add_f32_dpp v45, v45, v45 row_ror:8 row_mask:0xf bank_mask:0xf
  v_add_f32_dpp v42, v42, v42 row_ror:4 row_mask:0xf bank_mask:0xf
  v_add_f32_dpp v43, v43, v43 row_ror:4 row_mask:0xf bank_mask:0xf
  v_add_f32_dpp v44, v44, v44 row_ror:4 row_mask:0xf bank_mask:0xf
  v_add_f32_dpp v45, v45, v45 row_ror:4 row_mask:0xf bank_mask:0xf
  v_add_f32_dpp v42, v42, v42 row_ror:2 row_mask:0xf bank_mask:0xf
  v_add_f32_dpp v43, v43, v43 row_ror:2 row_mask:0xf bank_mask:0xf
  v_add_f32_dpp v44, v44, v44 row_ror:2 row_mask:0xf bank_mask:0xf
  v_add_f32_dpp v45, v45, v45 row_ror:2 row_mask:0xf bank_mask:0xf
  v_add_f32_dpp v42, v42, v42 row_ror:1 row_mask:0xf bank_mask:0xf
  v_add_f32_dpp v43, v43, v43 row_ror:1 row_mask:0xf bank_mask:0xf
  v_add_f32_dpp v44, v44, v44 row_ror:1 row_mask:0xf bank_mask:0xf
  v_add_f32_dpp v45, v45, v45 row_ror:1 row_mask:0xf bank_mask:0xf
  s_lshl_b64 s[6:7], s[4:5], 13
  v_cndmask_b32 v18, v18, v42, s[6:7]
  v_cndmask_b32 v19, v19, v43, s[6:7]
  v_cndmask_b32 v20, v20, v44, s[6:7]
  v_cndmask_b32 v21, v21, v45, s[6:7]
  s_waitcnt vmcnt(2)
  v_dot2_f32_bf16 v42, v88, v14, 0
  v_dot2_f32_bf16 v43, v92, v14, 0
  v_dot2_f32_bf16 v44, v96, v14, 0
  v_dot2_f32_bf16 v45, v100, v14, 0
  v_dot2_f32_bf16 v42, v89, v15, v42
  v_dot2_f32_bf16 v43, v93, v15, v43
  v_dot2_f32_bf16 v44, v97, v15, v44
  v_dot2_f32_bf16 v45, v101, v15, v45
  v_dot2_f32_bf16 v42, v90, v16, v42
  v_dot2_f32_bf16 v43, v94, v16, v43
  v_dot2_f32_bf16 v44, v98, v16, v44
  v_dot2_f32_bf16 v45, v102, v16, v45
  v_dot2_f32_bf16 v42, v91, v17, v42
  v_dot2_f32_bf16 v43, v95, v17, v43
  v_dot2_f32_bf16 v44, v99, v17, v44
  v_dot2_f32_bf16 v45, v103, v17, v45
  buffer_load_dwordx4 v[108:111], v8, s[32:35], s84 offen offset:256 nt
  buffer_load_dwordx4 v[112:115], v8, s[32:35], s84 offen offset:512 nt
  buffer_load_dwordx4 v[116:119], v8, s[32:35], s84 offen offset:768 nt
  s_add_u32 s84, s89, 0
  s_and_b32 s84, s84, 15
  s_lshl_b32 s84, s84, 15
  s_add_u32 s84, s84, s77
  buffer_load_dwordx4 v[120:123], v8, s[36:39], s84 offen offset:0 nt
  buffer_load_dwordx4 v[200:203], v10, s[44:47], s85 offen offset:512 nt
  v_add_f32_dpp v42, v42, v42 row_ror:8 row_mask:0xf bank_mask:0xf
  v_add_f32_dpp v43, v43, v43 row_ror:8 row_mask:0xf bank_mask:0xf
  v_add_f32_dpp v44, v44, v44 row_ror:8 row_mask:0xf bank_mask:0xf
  v_add_f32_dpp v45, v45, v45 row_ror:8 row_mask:0xf bank_mask:0xf
  v_add_f32_dpp v42, v42, v42 row_ror:4 row_mask:0xf bank_mask:0xf
  v_add_f32_dpp v43, v43, v43 row_ror:4 row_mask:0xf bank_mask:0xf
  v_add_f32_dpp v44, v44, v44 row_ror:4 row_mask:0xf bank_mask:0xf
  v_add_f32_dpp v45, v45, v45 row_ror:4 row_mask:0xf bank_mask:0xf
  v_add_f32_dpp v42, v42, v42 row_ror:2 row_mask:0xf bank_mask:0xf
  v_add_f32_dpp v43, v43, v43 row_ror:2 row_mask:0xf bank_mask:0xf
  v_add_f32_dpp v44, v44, v44 row_ror:2 row_mask:0xf bank_mask:0xf
  v_add_f32_dpp v45, v45, v45 row_ror:2 row_mask:0xf bank_mask:0xf
  v_add_f32_dpp v42, v42, v42 row_ror:1 row_mask:0xf bank_mask:0xf
  v_add_f32_dpp v43, v43, v43 row_ror:1 row_mask:0xf bank_mask:0xf
  v_add_f32_dpp v44, v44, v44 row_ror:1 row_mask:0xf bank_mask:0xf
  v_add_f32_dpp v45, v45, v45 row_ror:1 row_mask:0xf bank_mask:0xf
  s_lshl_b64 s[6:7], s[4:5], 14
  v_cndmask_b32 v18, v18, v42, s[6:7]
  v_cndmask_b32 v19, v19, v43, s[6:7]
  v_cndmask_b32 v20, v20, v44, s[6:7]
  v_cndmask_b32 v21, v21, v45, s[6:7]
  s_waitcnt vmcnt(2)
  v_dot2_f32_bf16 v42, v104, v14, 0
  v_dot2_f32_bf16 v43, v108, v14, 0
  v_dot2_f32_bf16 v44, v112, v14, 0
  v_dot2_f32_bf16 v45, v116, v14, 0
  v_dot2_f32_bf16 v42, v105, v15, v42
  v_dot2_f32_bf16 v43, v109, v15, v43
  v_dot2_f32_bf16 v44, v113, v15, v44
  v_dot2_f32_bf16 v45, v117, v15, v45
  v_dot2_f32_bf16 v42, v106, v16, v42
  v_dot2_f32_bf16 v43, v110, v16, v43
  v_dot2_f32_bf16 v44, v114, v16, v44
  v_dot2_f32_bf16 v45, v118, v16, v45
  v_dot2_f32_bf16 v42, v107, v17, v42
  v_dot2_f32_bf16 v43, v111, v17, v43
  v_dot2_f32_bf16 v44, v115, v17, v44
  v_dot2_f32_bf16 v45, v119, v17, v45
  buffer_load_dwordx4 v[124:127], v8, s[36:39], s84 offen offset:256 nt
  buffer_load_dwordx4 v[128:131], v8, s[36:39], s84 offen offset:512 nt
  buffer_load_dwordx4 v[132:135], v8, s[36:39], s84 offen offset:768 nt
  s_add_u32 s84, s89, 1
  s_and_b32 s84, s84, 15
  s_lshl_b32 s84, s84, 15
  s_add_u32 s84, s84, s77
  buffer_load_dwordx4 v[136:139], v8, s[36:39], s84 offen offset:0 nt
  buffer_load_dwordx4 v[204:207], v10, s[44:47], s85 offen offset:768 nt
  v_add_f32_dpp v42, v42, v42 row_ror:8 row_mask:0xf bank_mask:0xf
  v_add_f32_dpp v43, v43, v43 row_ror:8 row_mask:0xf bank_mask:0xf
  v_add_f32_dpp v44, v44, v44 row_ror:8 row_mask:0xf bank_mask:0xf
  v_add_f32_dpp v45, v45, v45 row_ror:8 row_mask:0xf bank_mask:0xf
  v_add_f32_dpp v42, v42, v42 row_ror:4 row_mask:0xf bank_mask:0xf
  v_add_f32_dpp v43, v43, v43 row_ror:4 row_mask:0xf bank_mask:0xf
  v_add_f32_dpp v44, v44, v44 row_ror:4 row_mask:0xf bank_mask:0xf
  v_add_f32_dpp v45, v45, v45 row_ror:4 row_mask:0xf bank_mask:0xf
  v_add_f32_dpp v42, v42, v42 row_ror:2 row_mask:0xf bank_mask:0xf
  v_add_f32_dpp v43, v43, v43 row_ror:2 row_mask:0xf bank_mask:0xf
  v_add_f32_dpp v44, v44, v44 row_ror:2 row_mask:0xf bank_mask:0xf
  v_add_f32_dpp v45, v45, v45 row_ror:2 row_mask:0xf bank_mask:0xf
  v_add_f32_dpp v42, v42, v42 row_ror:1 row_mask:0xf bank_mask:0xf
  v_add_f32_dpp v43, v43, v43 row_ror:1 row_mask:0xf bank_mask:0xf
  v_add_f32_dpp v44, v44, v44 row_ror:1 row_mask:0xf bank_mask:0xf
  v_add_f32_dpp v45, v45, v45 row_ror:1 row_mask:0xf bank_mask:0xf
  s_lshl_b64 s[6:7], s[4:5], 15
  v_cndmask_b32 v18, v18, v42, s[6:7]
  v_cndmask_b32 v19, v19, v43, s[6:7]
  v_cndmask_b32 v20, v20, v44, s[6:7]
  v_cndmask_b32 v21, v21, v45, s[6:7]
  v_cvt_pk_bf16_f32 v18, v18, v18
  v_and_b32 v18, 0xffff0000, v18
  v_cvt_pk_bf16_f32 v19, v19, v19
  v_and_b32 v19, 0xffff0000, v19
  v_cvt_pk_bf16_f32 v20, v20, v20
  v_and_b32 v20, 0xffff0000, v20
  v_cvt_pk_bf16_f32 v21, v21, v21
  v_and_b32 v21, 0xffff0000, v21
  v_mul_f32 v18, 0x3db504f3, v18
  v_mul_f32 v19, 0x3db504f3, v19
  v_mul_f32 v20, 0x3db504f3, v20
  v_mul_f32 v21, 0x3db504f3, v21
  v_cvt_pk_bf16_f32 v18, v18, v18
  v_and_b32 v18, 0xffff0000, v18
  v_cvt_pk_bf16_f32 v19, v19, v19
  v_and_b32 v19, 0xffff0000, v19
  v_cvt_pk_bf16_f32 v20, v20, v20
  v_and_b32 v20, 0xffff0000, v20
  v_cvt_pk_bf16_f32 v21, v21, v21
  v_and_b32 v21, 0xffff0000, v21
  v_max3_f32 v52, v18, v19, v20
  v_max_f32 v52, v52, v21
  s_nop 1
  v_max_f32_dpp v52, v52, v52 row_ror:8 row_mask:0xf bank_mask:0xf
  s_nop 1
  v_max_f32_dpp v52, v52, v52 row_ror:4 row_mask:0xf bank_mask:0xf
  s_nop 1
  v_max_f32_dpp v52, v52, v52 row_ror:2 row_mask:0xf bank_mask:0xf
  s_nop 1
  v_max_f32_dpp v52, v52, v52 row_ror:1 row_mask:0xf bank_mask:0xf
  s_nop 1
  v_mov_b32 v42, v52
  s_nop 1
  v_permlane16_swap_b32 v52, v42
  s_nop 0
  v_max_f32 v52, v52, v42
  v_mov_b32 v42, v52
  s_nop 1
  v_permlane32_swap_b32 v52, v42
  s_nop 0
  v_max_f32 v52, v52, v42
  v_sub_f32 v18, v18, v52
  v_sub_f32 v19, v19, v52
  v_sub_f32 v20, v20, v52
  v_sub_f32 v21, v21, v52
  v_mul_f32 v18, 0x3fb8aa3b, v18
  v_mul_f32 v19, 0x3fb8aa3b, v19
  v_mul_f32 v20, 0x3fb8aa3b, v20
  v_mul_f32 v21, 0x3fb8aa3b, v21
  v_exp_f32 v18, v18
  v_exp_f32 v19, v19
  v_exp_f32 v20, v20
  v_exp_f32 v21, v21
  s_nop 0
  v_add_f32 v53, v18, v19
  v_add_f32 v42, v20, v21
  v_add_f32 v53, v53, v42
  s_nop 1
  v_add_f32_dpp v53, v53, v53 row_ror:8 row_mask:0xf bank_mask:0xf
  s_nop 1
  v_add_f32_dpp v53, v53, v53 row_ror:4 row_mask:0xf bank_mask:0xf
  s_nop 1
  v_add_f32_dpp v53, v53, v53 row_ror:2 row_mask:0xf bank_mask:0xf
  s_nop 1
  v_add_f32_dpp v53, v53, v53 row_ror:1 row_mask:0xf bank_mask:0xf
  s_nop 1
  v_mov_b32 v42, v53
  s_nop 1
  v_permlane16_swap_b32 v53, v42
  s_nop 0
  v_add_f32 v53, v53, v42
  v_mov_b32 v42, v53
  s_nop 1
  v_permlane32_swap_b32 v53, v42
  s_nop 0
  v_add_f32 v53, v53, v42
  v_cvt_pk_bf16_f32 v18, v18, v18
  v_cvt_pk_bf16_f32 v19, v19, v19
  v_cvt_pk_bf16_f32 v20, v20, v20
  v_cvt_pk_bf16_f32 v21, v21, v21
  s_lshl_b32 s82, s72, 3
  v_mov_b32 v42, s82
  v_mov_b32 v43, 0
  v_mov_b32 v44, 1
  s_mov_b64 exec, 1
  ds_write_b64 v42, v[52:53] offset:12352
  ds_add_u32 v43, v44 offset:12416
  s_mov_b64 exec, -1
  v_and_b32_dpp v26, v18, v4 row_newbcast:0 row_mask:0xf bank_mask:0xf
  v_and_b32_dpp v27, v18, v5 row_newbcast:0 row_mask:0xf bank_mask:0xf
  v_and_b32_dpp v28, v18, v6 row_newbcast:0 row_mask:0xf bank_mask:0xf
  v_and_b32_dpp v29, v18, v7 row_newbcast:0 row_mask:0xf bank_mask:0xf
  v_and_b32_dpp v30, v19, v4 row_newbcast:0 row_mask:0xf bank_mask:0xf
  v_and_b32_dpp v31, v19, v5 row_newbcast:0 row_mask:0xf bank_mask:0xf
  v_and_b32_dpp v32, v19, v6 row_newbcast:0 row_mask:0xf bank_mask:0xf
  v_and_b32_dpp v33, v19, v7 row_newbcast:0 row_mask:0xf bank_mask:0xf
  v_and_b32_dpp v34, v20, v4 row_newbcast:0 row_mask:0xf bank_mask:0xf
  v_and_b32_dpp v35, v20, v5 row_newbcast:0 row_mask:0xf bank_mask:0xf
  v_and_b32_dpp v36, v20, v6 row_newbcast:0 row_mask:0xf bank_mask:0xf
  v_and_b32_dpp v37, v20, v7 row_newbcast:0 row_mask:0xf bank_mask:0xf
  v_and_b32_dpp v38, v21, v4 row_newbcast:0 row_mask:0xf bank_mask:0xf
  v_and_b32_dpp v39, v21, v5 row_newbcast:0 row_mask:0xf bank_mask:0xf
  v_and_b32_dpp v40, v21, v6 row_newbcast:0 row_mask:0xf bank_mask:0xf
  v_and_b32_dpp v41, v21, v7 row_newbcast:0 row_mask:0xf bank_mask:0xf
  s_waitcnt vmcnt(2)
  v_mfma_f32_16x16x32_bf16 v[22:25], v[26:29], v[120:123], 0
  v_mfma_f32_16x16x32_bf16 v[22:25], v[30:33], v[124:127], v[22:25]
  v_mfma_f32_16x16x32_bf16 v[22:25], v[34:37], v[128:131], v[22:25]
  v_mfma_f32_16x16x32_bf16 v[22:25], v[38:41], v[132:135], v[22:25]
  buffer_load_dwordx4 v[140:143], v8, s[36:39], s84 offen offset:256 nt
  buffer_load_dwordx4 v[144:147], v8, s[36:39], s84 offen offset:512 nt
  buffer_load_dwordx4 v[148:151], v8, s[36:39], s84 offen offset:768 nt
  s_add_u32 s84, s89, 2
  s_and_b32 s84, s84, 15
  s_lshl_b32 s84, s84, 15
  s_add_u32 s84, s84, s77
  buffer_load_dwordx4 v[56:59], v8, s[36:39], s84 offen offset:0 nt
  v_and_b32_dpp v26, v18, v4 row_newbcast:1 row_mask:0xf bank_mask:0xf
  v_and_b32_dpp v27, v18, v5 row_newbcast:1 row_mask:0xf bank_mask:0xf
  v_and_b32_dpp v28, v18, v6 row_newbcast:1 row_mask:0xf bank_mask:0xf
  v_and_b32_dpp v29, v18, v7 row_newbcast:1 row_mask:0xf bank_mask:0xf
  v_and_b32_dpp v30, v19, v4 row_newbcast:1 row_mask:0xf bank_mask:0xf
  v_and_b32_dpp v31, v19, v5 row_newbcast:1 row_mask:0xf bank_mask:0xf
  v_and_b32_dpp v32, v19, v6 row_newbcast:1 row_mask:0xf bank_mask:0xf
  v_and_b32_dpp v33, v19, v7 row_newbcast:1 row_mask:0xf bank_mask:0xf
  v_and_b32_dpp v34, v20, v4 row_newbcast:1 row_mask:0xf bank_mask:0xf
  v_and_b32_dpp v35, v20, v5 row_newbcast:1 row_mask:0xf bank_mask:0xf
  v_and_b32_dpp v36, v20, v6 row_newbcast:1 row_mask:0xf bank_mask:0xf
  v_and_b32_dpp v37, v20, v7 row_newbcast:1 row_mask:0xf bank_mask:0xf
  v_and_b32_dpp v38, v21, v4 row_newbcast:1 row_mask:0xf bank_mask:0xf
  v_and_b32_dpp v39, v21, v5 row_newbcast:1 row_mask:0xf bank_mask:0xf
  v_and_b32_dpp v40, v21, v6 row_newbcast:1 row_mask:0xf bank_mask:0xf
  v_and_b32_dpp v41, v21, v7 row_newbcast:1 row_mask:0xf bank_mask:0xf
  s_waitcnt vmcnt(1)
  v_mfma_f32_16x16x32_bf16 v[22:25], v[26:29], v[136:139], v[22:25]
  v_mfma_f32_16x16x32_bf16 v[22:25], v[30:33], v[140:143], v[22:25]
  v_mfma_f32_16x16x32_bf16 v[22:25], v[34:37], v[144:147], v[22:25]
  v_mfma_f32_16x16x32_bf16 v[22:25], v[38:41], v[148:151], v[22:25]
  buffer_load_dwordx4 v[60:63], v8, s[36:39], s84 offen offset:256 nt
  buffer_load_dwordx4 v[64:67], v8, s[36:39], s84 offen offset:512 nt
  buffer_load_dwordx4 v[68:71], v8, s[36:39], s84 offen offset:768 nt
  s_add_u32 s84, s89, 3
  s_and_b32 s84, s84, 15
  s_lshl_b32 s84, s84, 15
  s_add_u32 s84, s84, s77
  buffer_load_dwordx4 v[72:75], v8, s[36:39], s84 offen offset:0 nt
  buffer_load_dwordx4 v[208:211], v10, s[44:47], s85 offen offset:1024 nt
  v_and_b32 v42, 7, v2
  v_lshlrev_b32 v42, 10, v42
  v_lshrrev_b32 v43, 3, v2
  v_lshl_add_u32 v42, v43, 9, v42
  v_lshrrev_b32 v43, 1, v3
  v_lshl_add_u32 v46, v43, 4, v42
  s_cmp_lt_u32 s88, 54
  s_cselect_b32 s10, s10, 0x20000000
  buffer_load_dwordx4 v[48:51], v46, s[68:71], s10 offen sc1
  v_and_b32_dpp v26, v18, v4 row_newbcast:2 row_mask:0xf bank_mask:0xf
  v_and_b32_dpp v27, v18, v5 row_newbcast:2 row_mask:0xf bank_mask:0xf
  v_and_b32_dpp v28, v18, v6 row_newbcast:2 row_mask:0xf bank_mask:0xf
  v_and_b32_dpp v29, v18, v7 row_newbcast:2 row_mask:0xf bank_mask:0xf
  v_and_b32_dpp v30, v19, v4 row_newbcast:2 row_mask:0xf bank_mask:0xf
  v_and_b32_dpp v31, v19, v5 row_newbcast:2 row_mask:0xf bank_mask:0xf
  v_and_b32_dpp v32, v19, v6 row_newbcast:2 row_mask:0xf bank_mask:0xf
  v_and_b32_dpp v33, v19, v7 row_newbcast:2 row_mask:0xf bank_mask:0xf
  v_and_b32_dpp v34, v20, v4 row_newbcast:2 row_mask:0xf bank_mask:0xf
  v_and_b32_dpp v35, v20, v5 row_newbcast:2 row_mask:0xf bank_mask:0xf
  v_and_b32_dpp v36, v20, v6 row_newbcast:2 row_mask:0xf bank_mask:0xf
  v_and_b32_dpp v37, v20, v7 row_newbcast:2 row_mask:0xf bank_mask:0xf
  v_and_b32_dpp v38, v21, v4 row_newbcast:2 row_mask:0xf bank_mask:0xf
  v_and_b32_dpp v39, v21, v5 row_newbcast:2 row_mask:0xf bank_mask:0xf
  v_and_b32_dpp v40, v21, v6 row_newbcast:2 row_mask:0xf bank_mask:0xf
  v_and_b32_dpp v41, v21, v7 row_newbcast:2 row_mask:0xf bank_mask:0xf
  s_waitcnt vmcnt(3)
  v_mfma_f32_16x16x32_bf16 v[22:25], v[26:29], v[56:59], v[22:25]
  v_mfma_f32_16x16x32_bf16 v[22:25], v[30:33], v[60:63], v[22:25]
  v_mfma_f32_16x16x32_bf16 v[22:25], v[34:37], v[64:67], v[22:25]
  v_mfma_f32_16x16x32_bf16 v[22:25], v[38:41], v[68:71], v[22:25]
  buffer_load_dwordx4 v[76:79], v8, s[36:39], s84 offen offset:256 nt
  buffer_load_dwordx4 v[80:83], v8, s[36:39], s84 offen offset:512 nt
  buffer_load_dwordx4 v[84:87], v8, s[36:39], s84 offen offset:768 nt
  s_add_u32 s84, s89, 4
  s_and_b32 s84, s84, 15
  s_lshl_b32 s84, s84, 15
  s_add_u32 s84, s84, s77
  buffer_load_dwordx4 v[88:91], v8, s[36:39], s84 offen offset:0 nt
  s_add_u32 s85, s79, 3840
  buffer_load_dwordx4 v[212:215], v10, s[44:47], s85 offen offset:0 nt
  v_and_b32_dpp v26, v18, v4 row_newbcast:3 row_mask:0xf bank_mask:0xf
  v_and_b32_dpp v27, v18, v5 row_newbcast:3 row_mask:0xf bank_mask:0xf
  v_and_b32_dpp v28, v18, v6 row_newbcast:3 row_mask:0xf bank_mask:0xf
  v_and_b32_dpp v29, v18, v7 row_newbcast:3 row_mask:0xf bank_mask:0xf
  v_and_b32_dpp v30, v19, v4 row_newbcast:3 row_mask:0xf bank_mask:0xf
  v_and_b32_dpp v31, v19, v5 row_newbcast:3 row_mask:0xf bank_mask:0xf
  v_and_b32_dpp v32, v19, v6 row_newbcast:3 row_mask:0xf bank_mask:0xf
  v_and_b32_dpp v33, v19, v7 row_newbcast:3 row_mask:0xf bank_mask:0xf
  v_and_b32_dpp v34, v20, v4 row_newbcast:3 row_mask:0xf bank_mask:0xf
  v_and_b32_dpp v35, v20, v5 row_newbcast:3 row_mask:0xf bank_mask:0xf
  v_and_b32_dpp v36, v20, v6 row_newbcast:3 row_mask:0xf bank_mask:0xf
  v_and_b32_dpp v37, v20, v7 row_newbcast:3 row_mask:0xf bank_mask:0xf
  v_and_b32_dpp v38, v21, v4 row_newbcast:3 row_mask:0xf bank_mask:0xf
  v_and_b32_dpp v39, v21, v5 row_newbcast:3 row_mask:0xf bank_mask:0xf
  v_and_b32_dpp v40, v21, v6 row_newbcast:3 row_mask:0xf bank_mask:0xf
  v_and_b32_dpp v41, v21, v7 row_newbcast:3 row_mask:0xf bank_mask:0xf
  s_waitcnt vmcnt(2)
  v_mfma_f32_16x16x32_bf16 v[22:25], v[26:29], v[72:75], v[22:25]
  v_mfma_f32_16x16x32_bf16 v[22:25], v[30:33], v[76:79], v[22:25]
  v_mfma_f32_16x16x32_bf16 v[22:25], v[34:37], v[80:83], v[22:25]
  v_mfma_f32_16x16x32_bf16 v[22:25], v[38:41], v[84:87], v[22:25]
  buffer_load_dwordx4 v[92:95], v8, s[36:39], s84 offen offset:256 nt
  buffer_load_dwordx4 v[96:99], v8, s[36:39], s84 offen offset:512 nt
  buffer_load_dwordx4 v[100:103], v8, s[36:39], s84 offen offset:768 nt
  s_add_u32 s84, s89, 5
  s_and_b32 s84, s84, 15
  s_lshl_b32 s84, s84, 15
  s_add_u32 s84, s84, s77
  buffer_load_dwordx4 v[104:107], v8, s[36:39], s84 offen offset:0 nt
  buffer_load_dwordx4 v[216:219], v10, s[44:47], s85 offen offset:256 nt
  v_and_b32_dpp v26, v18, v4 row_newbcast:4 row_mask:0xf bank_mask:0xf
  v_and_b32_dpp v27, v18, v5 row_newbcast:4 row_mask:0xf bank_mask:0xf
  v_and_b32_dpp v28, v18, v6 row_newbcast:4 row_mask:0xf bank_mask:0xf
  v_and_b32_dpp v29, v18, v7 row_newbcast:4 row_mask:0xf bank_mask:0xf
  v_and_b32_dpp v30, v19, v4 row_newbcast:4 row_mask:0xf bank_mask:0xf
  v_and_b32_dpp v31, v19, v5 row_newbcast:4 row_mask:0xf bank_mask:0xf
  v_and_b32_dpp v32, v19, v6 row_newbcast:4 row_mask:0xf bank_mask:0xf
  v_and_b32_dpp v33, v19, v7 row_newbcast:4 row_mask:0xf bank_mask:0xf
  v_and_b32_dpp v34, v20, v4 row_newbcast:4 row_mask:0xf bank_mask:0xf
  v_and_b32_dpp v35, v20, v5 row_newbcast:4 row_mask:0xf bank_mask:0xf
  v_and_b32_dpp v36, v20, v6 row_newbcast:4 row_mask:0xf bank_mask:0xf
  v_and_b32_dpp v37, v20, v7 row_newbcast:4 row_mask:0xf bank_mask:0xf
  v_and_b32_dpp v38, v21, v4 row_newbcast:4 row_mask:0xf bank_mask:0xf
  v_and_b32_dpp v39, v21, v5 row_newbcast:4 row_mask:0xf bank_mask:0xf
  v_and_b32_dpp v40, v21, v6 row_newbcast:4 row_mask:0xf bank_mask:0xf
  v_and_b32_dpp v41, v21, v7 row_newbcast:4 row_mask:0xf bank_mask:0xf
  s_waitcnt vmcnt(2)
  v_mfma_f32_16x16x32_bf16 v[22:25], v[26:29], v[88:91], v[22:25]
  v_mfma_f32_16x16x32_bf16 v[22:25], v[30:33], v[92:95], v[22:25]
  v_mfma_f32_16x16x32_bf16 v[22:25], v[34:37], v[96:99], v[22:25]
  v_mfma_f32_16x16x32_bf16 v[22:25], v[38:41], v[100:103], v[22:25]
  buffer_load_dwordx4 v[108:111], v8, s[36:39], s84 offen offset:256 nt
  buffer_load_dwordx4 v[112:115], v8, s[36:39], s84 offen offset:512 nt
  buffer_load_dwordx4 v[116:119], v8, s[36:39], s84 offen offset:768 nt
  s_add_u32 s84, s89, 6
  s_and_b32 s84, s84, 15
  s_lshl_b32 s84, s84, 15
  s_add_u32 s84, s84, s77
  buffer_load_dwordx4 v[120:123], v8, s[36:39], s84 offen offset:0 nt
  buffer_load_dwordx4 v[220:223], v10, s[44:47], s85 offen offset:512 nt
  s_cmp_lg_u32 s72, 0
  s_cbranch_scc1 L_noml_3
  v_mov_b32 v54, 0
  s_mov_b32 s16, 40000
L_stp_spin_4:
  ds_read_b32 v55, v54 offset:12416
  s_waitcnt lgkmcnt(0)
  v_readfirstlane_b32 s82, v55
  s_nop 2
  s_cmp_ge_u32 s82, 8
  s_cbranch_scc1 L_stp_ok_5
  s_sub_u32 s16, s16, 1
  s_cmp_eq_u32 s16, 0
  s_cbranch_scc1 L_stp_ok_5
  s_sleep 2
  s_branch L_stp_spin_4
L_stp_ok_5:
  v_lshrrev_b32 v34, 2, v2
  v_lshlrev_b32 v34, 4, v34
  ds_read_b128 v[26:29], v34 offset:12352
  s_waitcnt lgkmcnt(0)
  v_max_f32 v30, v26, v28
  s_nop 1
  v_max_f32_dpp v30, v30, v30 row_ror:4 row_mask:0xf bank_mask:0xf
  s_nop 1
  v_max_f32_dpp v30, v30, v30 row_ror:8 row_mask:0xf bank_mask:0xf
  s_nop 1
  v_sub_f32 v31, v26, v30
  v_sub_f32 v32, v28, v30
  v_mul_f32 v31, 0x3fb8aa3b, v31
  v_mul_f32 v32, 0x3fb8aa3b, v32
  v_exp_f32 v31, v31
  v_exp_f32 v32, v32
  s_nop 0
  v_mul_f32 v31, v31, v27
  v_fmac_f32 v31, v32, v29
  s_nop 1
  v_add_f32_dpp v31, v31, v31 row_ror:4 row_mask:0xf bank_mask:0xf
  s_nop 1
  v_add_f32_dpp v31, v31, v31 row_ror:8 row_mask:0xf bank_mask:0xf
  s_nop 1
  v_mov_b32 v32, s90
  v_mov_b32 v33, s91
  s_mov_b64 exec, 1
  buffer_store_dwordx4 v[30:33], off, s[68:71], s12 sc1
  s_mov_b64 exec, -1
  s_nop 1
L_noml_3:
  v_and_b32_dpp v26, v18, v4 row_newbcast:5 row_mask:0xf bank_mask:0xf
  v_and_b32_dpp v27, v18, v5 row_newbcast:5 row_mask:0xf bank_mask:0xf
  v_and_b32_dpp v28, v18, v6 row_newbcast:5 row_mask:0xf bank_mask:0xf
  v_and_b32_dpp v29, v18, v7 row_newbcast:5 row_mask:0xf bank_mask:0xf
  v_and_b32_dpp v30, v19, v4 row_newbcast:5 row_mask:0xf bank_mask:0xf
  v_and_b32_dpp v31, v19, v5 row_newbcast:5 row_mask:0xf bank_mask:0xf
  v_and_b32_dpp v32, v19, v6 row_newbcast:5 row_mask:0xf bank_mask:0xf
  v_and_b32_dpp v33, v19, v7 row_newbcast:5 row_mask:0xf bank_mask:0xf
  v_and_b32_dpp v34, v20, v4 row_newbcast:5 row_mask:0xf bank_mask:0xf
  v_and_b32_dpp v35, v20, v5 row_newbcast:5 row_mask:0xf bank_mask:0xf
  v_and_b32_dpp v36, v20, v6 row_newbcast:5 row_mask:0xf bank_mask:0xf
  v_and_b32_dpp v37, v20, v7 row_newbcast:5 row_mask:0xf bank_mask:0xf
  v_and_b32_dpp v38, v21, v4 row_newbcast:5 row_mask:0xf bank_mask:0xf
  v_and_b32_dpp v39, v21, v5 row_newbcast:5 row_mask:0xf bank_mask:0xf
  v_and_b32_dpp v40, v21, v6 row_newbcast:5 row_mask:0xf bank_mask:0xf
  v_and_b32_dpp v41, v21, v7 row_newbcast:5 row_mask:0xf bank_mask:0xf
  s_waitcnt vmcnt(2)
  v_mfma_f32_16x16x32_bf16 v[22:25], v[26:29], v[104:107], v[22:25]
  v_mfma_f32_16x16x32_bf16 v[22:25], v[30:33], v[108:111], v[22:25]
  v_mfma_f32_16x16x32_bf16 v[22:25], v[34:37], v[112:115], v[22:25]
  v_mfma_f32_16x16x32_bf16 v[22:25], v[38:41], v[116:119], v[22:25]
  buffer_load_dwordx4 v[124:127], v8, s[36:39], s84 offen offset:256 nt
  buffer_load_dwordx4 v[128:131], v8, s[36:39], s84 offen offset:512 nt
  buffer_load_dwordx4 v[132:135], v8, s[36:39], s84 offen offset:768 nt
  s_add_u32 s84, s89, 7
  s_and_b32 s84, s84, 15
  s_lshl_b32 s84, s84, 15
  s_add_u32 s84, s84, s77
  buffer_load_dwordx4 v[136:139], v8, s[36:39], s84 offen offset:0 nt
  buffer_load_dwordx4 v[224:227], v10, s[44:47], s85 offen offset:768 nt
  v_mov_b32 v47, 0
  s_cmp_ge_u32 s88, 54
  s_cbranch_scc1 L_nohid_6
  v_xor_b32 v54, s90, v50
  v_xor_b32 v55, s91, v51
  v_or_b32 v54, v54, v55
  v_cmp_ne_u32 vcc, 0, v54
  s_nop 4
  s_cmp_eq_u64 vcc, 0
  s_cbranch_scc1 L_gu_ok_9
  s_mov_b32 s16, 40000
L_gu_spin_8:
  s_sleep 2
  buffer_load_dwordx4 v[48:51], v46, s[68:71], s10 offen sc1
  s_waitcnt vmcnt(0)
  s_sub_u32 s16, s16, 1
  s_cmp_eq_u32 s16, 0
  s_cbranch_scc1 L_gu_ok_9
  v_xor_b32 v54, s90, v50
  v_xor_b32 v55, s91, v51
  v_or_b32 v54, v54, v55
  v_cmp_ne_u32 vcc, 0, v54
  s_nop 4
  s_cmp_eq_u64 vcc, 0
  s_cbranch_scc0 L_gu_spin_8
L_gu_ok_9:
  v_and_b32 v42, 1, v3
  v_cmp_eq_u32 vcc, 1, v42
  s_nop 1
  v_cndmask_b32 v45, v48, v49, vcc
  s_nop 1
  v_add_f32_dpp v45, v45, v45 quad_perm:[1,0,3,2] row_mask:0xf bank_mask:0xf
  s_nop 1
  v_add_f32_dpp v45, v45, v45 quad_perm:[2,3,0,1] row_mask:0xf bank_mask:0xf
  s_nop 1
  v_add_f32_dpp v45, v45, v45 row_half_mirror row_mask:0xf bank_mask:0xf
  s_nop 1
  v_mov_b32_dpp v42, v45 row_ror:8 row_mask:0xf bank_mask:0xf
  v_cmp_gt_u32 vcc, 8, v2
  s_nop 1
  v_cndmask_b32 v43, v42, v45, vcc
  v_cndmask_b32 v44, v45, v42, vcc
  v_cvt_pk_bf16_f32 v43, v43, v43
  v_and_b32 v43, 0xffff0000, v43
  v_cvt_pk_bf16_f32 v44, v44, v44
  v_and_b32 v44, 0xffff0000, v44
  v_mul_f32 v42, v43, v43
  v_mul_f32 v42, v42, v43
  v_mul_f32 v42, 0x3d372713, v42
  v_add_f32 v42, v42, v43
  v_mul_f32 v42, 0x40135761, v42
  v_exp_f32 v42, v42
  s_nop 0
  v_add_f32 v42, 1.0, v42
  v_rcp_f32 v42, v42
  s_nop 0
  v_sub_f32 v42, 1.0, v42
  v_mul_f32 v42, v42, v43
  v_cvt_pk_bf16_f32 v42, v42, v42
  v_and_b32 v42, 0xffff0000, v42
  v_mul_f32 v42, v42, v44
  v_cvt_pk_bf16_f32 v47, v42, v42
L_nohid_6:
  v_and_b32_dpp v26, v18, v4 row_newbcast:6 row_mask:0xf bank_mask:0xf
  v_and_b32_dpp v27, v18, v5 row_newbcast:6 row_mask:0xf bank_mask:0xf
  v_and_b32_dpp v28, v18, v6 row_newbcast:6 row_mask:0xf bank_mask:0xf
  v_and_b32_dpp v29, v18, v7 row_newbcast:6 row_mask:0xf bank_mask:0xf
  v_and_b32_dpp v30, v19, v4 row_newbcast:6 row_mask:0xf bank_mask:0xf
  v_and_b32_dpp v31, v19, v5 row_newbcast:6 row_mask:0xf bank_mask:0xf
  v_and_b32_dpp v32, v19, v6 row_newbcast:6 row_mask:0xf bank_mask:0xf
  v_and_b32_dpp v33, v19, v7 row_newbcast:6 row_mask:0xf bank_mask:0xf
  v_and_b32_dpp v34, v20, v4 row_newbcast:6 row_mask:0xf bank_mask:0xf
  v_and_b32_dpp v35, v20, v5 row_newbcast:6 row_mask:0xf bank_mask:0xf
  v_and_b32_dpp v36, v20, v6 row_newbcast:6 row_mask:0xf bank_mask:0xf
  v_and_b32_dpp v37, v20, v7 row_newbcast:6 row_mask:0xf bank_mask:0xf
  v_and_b32_dpp v38, v21, v4 row_newbcast:6 row_mask:0xf bank_mask:0xf
  v_and_b32_dpp v39, v21, v5 row_newbcast:6 row_mask:0xf bank_mask:0xf
  v_and_b32_dpp v40, v21, v6 row_newbcast:6 row_mask:0xf bank_mask:0xf
  v_and_b32_dpp v41, v21, v7 row_newbcast:6 row_mask:0xf bank_mask:0xf
  s_waitcnt vmcnt(2)
  v_mfma_f32_16x16x32_bf16 v[22:25], v[26:29], v[120:123], v[22:25]
  v_mfma_f32_16x16x32_bf16 v[22:25], v[30:33], v[124:127], v[22:25]
  v_mfma_f32_16x16x32_bf16 v[22:25], v[34:37], v[128:131], v[22:25]
  v_mfma_f32_16x16x32_bf16 v[22:25], v[38:41], v[132:135], v[22:25]
  buffer_load_dwordx4 v[140:143], v8, s[36:39], s84 offen offset:256 nt
  buffer_load_dwordx4 v[144:147], v8, s[36:39], s84 offen offset:512 nt
  buffer_load_dwordx4 v[148:151], v8, s[36:39], s84 offen offset:768 nt
  s_add_u32 s84, s89, 8
  s_and_b32 s84, s84, 15
  s_lshl_b32 s84, s84, 15
  s_add_u32 s84, s84, s77
  buffer_load_dwordx4 v[56:59], v8, s[36:39], s84 offen offset:0 nt
  buffer_load_dwordx4 v[228:231], v10, s[44:47], s85 offen offset:1024 nt
  v_and_b32_dpp v26, v18, v4 row_newbcast:7 row_mask:0xf bank_mask:0xf
  v_and_b32_dpp v27, v18, v5 row_newbcast:7 row_mask:0xf bank_mask:0xf
  v_and_b32_dpp v28, v18, v6 row_newbcast:7 row_mask:0xf bank_mask:0xf
  v_and_b32_dpp v29, v18, v7 row_newbcast:7 row_mask:0xf bank_mask:0xf
  v_and_b32_dpp v30, v19, v4 row_newbcast:7 row_mask:0xf bank_mask:0xf
  v_and_b32_dpp v31, v19, v5 row_newbcast:7 row_mask:0xf bank_mask:0xf
  v_and_b32_dpp v32, v19, v6 row_newbcast:7 row_mask:0xf bank_mask:0xf
  v_and_b32_dpp v33, v19, v7 row_newbcast:7 row_mask:0xf bank_mask:0xf
  v_and_b32_dpp v34, v20, v4 row_newbcast:7 row_mask:0xf bank_mask:0xf
  v_and_b32_dpp v35, v20, v5 row_newbcast:7 row_mask:0xf bank_mask:0xf
  v_and_b32_dpp v36, v20, v6 row_newbcast:7 row_mask:0xf bank_mask:0xf
  v_and_b32_dpp v37, v20, v7 row_newbcast:7 row_mask:0xf bank_mask:0xf
  v_and_b32_dpp v38, v21, v4 row_newbcast:7 row_mask:0xf bank_mask:0xf
  v_and_b32_dpp v39, v21, v5 row_newbcast:7 row_mask:0xf bank_mask:0xf
  v_and_b32_dpp v40, v21, v6 row_newbcast:7 row_mask:0xf bank_mask:0xf
  v_and_b32_dpp v41, v21, v7 row_newbcast:7 row_mask:0xf bank_mask:0xf
  s_waitcnt vmcnt(2)
  v_mfma_f32_16x16x32_bf16 v[22:25], v[26:29], v[136:139], v[22:25]
  v_mfma_f32_16x16x32_bf16 v[22:25], v[30:33], v[140:143], v[22:25]
  v_mfma_f32_16x16x32_bf16 v[22:25], v[34:37], v[144:147], v[22:25]
  v_mfma_f32_16x16x32_bf16 v[22:25], v[38:41], v[148:151], v[22:25]
  buffer_load_dwordx4 v[60:63], v8, s[36:39], s84 offen offset:256 nt
  buffer_load_dwordx4 v[64:67], v8, s[36:39], s84 offen offset:512 nt
  buffer_load_dwordx4 v[68:71], v8, s[36:39], s84 offen offset:768 nt
  s_add_u32 s84, s89, 9
  s_and_b32 s84, s84, 15
  s_lshl_b32 s84, s84, 15
  s_add_u32 s84, s84, s77
  buffer_load_dwordx4 v[72:75], v8, s[36:39], s84 offen offset:0 nt
  buffer_load_dwordx4 v[232:235], v11, s[56:59], s80 offen offset:0 nt
  v_and_b32_dpp v26, v18, v4 row_newbcast:8 row_mask:0xf bank_mask:0xf
  v_and_b32_dpp v27, v18, v5 row_newbcast:8 row_mask:0xf bank_mask:0xf
  v_and_b32_dpp v28, v18, v6 row_newbcast:8 row_mask:0xf bank_mask:0xf
  v_and_b32_dpp v29, v18, v7 row_newbcast:8 row_mask:0xf bank_mask:0xf
  v_and_b32_dpp v30, v19, v4 row_newbcast:8 row_mask:0xf bank_mask:0xf
  v_and_b32_dpp v31, v19, v5 row_newbcast:8 row_mask:0xf bank_mask:0xf
  v_and_b32_dpp v32, v19, v6 row_newbcast:8 row_mask:0xf bank_mask:0xf
  v_and_b32_dpp v33, v19, v7 row_newbcast:8 row_mask:0xf bank_mask:0xf
  v_and_b32_dpp v34, v20, v4 row_newbcast:8 row_mask:0xf bank_mask:0xf
  v_and_b32_dpp v35, v20, v5 row_newbcast:8 row_mask:0xf bank_mask:0xf
  v_and_b32_dpp v36, v20, v6 row_newbcast:8 row_mask:0xf bank_mask:0xf
  v_and_b32_dpp v37, v20, v7 row_newbcast:8 row_mask:0xf bank_mask:0xf
  v_and_b32_dpp v38, v21, v4 row_newbcast:8 row_mask:0xf bank_mask:0xf
  v_and_b32_dpp v39, v21, v5 row_newbcast:8 row_mask:0xf bank_mask:0xf
  v_and_b32_dpp v40, v21, v6 row_newbcast:8 row_mask:0xf bank_mask:0xf
  v_and_b32_dpp v41, v21, v7 row_newbcast:8 row_mask:0xf bank_mask:0xf
  s_waitcnt vmcnt(2)
  v_mfma_f32_16x16x32_bf16 v[22:25], v[26:29], v[56:59], v[22:25]
  v_mfma_f32_16x16x32_bf16 v[22:25], v[30:33], v[60:63], v[22:25]
  v_mfma_f32_16x16x32_bf16 v[22:25], v[34:37], v[64:67], v[22:25]
  v_mfma_f32_16x16x32_bf16 v[22:25], v[38:41], v[68:71], v[22:25]
  buffer_load_dwordx4 v[76:79], v8, s[36:39], s84 offen offset:256 nt
  buffer_load_dwordx4 v[80:83], v8, s[36:39], s84 offen offset:512 nt
  buffer_load_dwordx4 v[84:87], v8, s[36:39], s84 offen offset:768 nt
  s_add_u32 s84, s89, 10
  s_and_b32 s84, s84, 15
  s_lshl_b32 s84, s84, 15
  s_add_u32 s84, s84, s77
  buffer_load_dwordx4 v[88:91], v8, s[36:39], s84 offen offset:0 nt
  buffer_load_dwordx4 v[236:239], v11, s[56:59], s80 offen offset:256 nt
  v_and_b32_dpp v26, v18, v4 row_newbcast:9 row_mask:0xf bank_mask:0xf
  v_and_b32_dpp v27, v18, v5 row_newbcast:9 row_mask:0xf bank_mask:0xf
  v_and_b32_dpp v28, v18, v6 row_newbcast:9 row_mask:0xf bank_mask:0xf
  v_and_b32_dpp v29, v18, v7 row_newbcast:9 row_mask:0xf bank_mask:0xf
  v_and_b32_dpp v30, v19, v4 row_newbcast:9 row_mask:0xf bank_mask:0xf
  v_and_b32_dpp v31, v19, v5 row_newbcast:9 row_mask:0xf bank_mask:0xf
  v_and_b32_dpp v32, v19, v6 row_newbcast:9 row_mask:0xf bank_mask:0xf
  v_and_b32_dpp v33, v19, v7 row_newbcast:9 row_mask:0xf bank_mask:0xf
  v_and_b32_dpp v34, v20, v4 row_newbcast:9 row_mask:0xf bank_mask:0xf
  v_and_b32_dpp v35, v20, v5 row_newbcast:9 row_mask:0xf bank_mask:0xf
  v_and_b32_dpp v36, v20, v6 row_newbcast:9 row_mask:0xf bank_mask:0xf
  v_and_b32_dpp v37, v20, v7 row_newbcast:9 row_mask:0xf bank_mask:0xf
  v_and_b32_dpp v38, v21, v4 row_newbcast:9 row_mask:0xf bank_mask:0xf
  v_and_b32_dpp v39, v21, v5 row_newbcast:9 row_mask:0xf bank_mask:0xf
  v_and_b32_dpp v40, v21, v6 row_newbcast:9 row_mask:0xf bank_mask:0xf
  v_and_b32_dpp v41, v21, v7 row_newbcast:9 row_mask:0xf bank_mask:0xf
  s_waitcnt vmcnt(2)
  v_mfma_f32_16x16x32_bf16 v[22:25], v[26:29], v[72:75], v[22:25]
  v_mfma_f32_16x16x32_bf16 v[22:25], v[30:33], v[76:79], v[22:25]
  v_mfma_f32_16x16x32_bf16 v[22:25], v[34:37], v[80:83], v[22:25]
  v_mfma_f32_16x16x32_bf16 v[22:25], v[38:41], v[84:87], v[22:25]
  buffer_load_dwordx4 v[92:95], v8, s[36:39], s84 offen offset:256 nt
  buffer_load_dwordx4 v[96:99], v8, s[36:39], s84 offen offset:512 nt
  buffer_load_dwordx4 v[100:103], v8, s[36:39], s84 offen offset:768 nt
  s_add_u32 s84, s89, 11
  s_and_b32 s84, s84, 15
  s_lshl_b32 s84, s84, 15
  s_add_u32 s84, s84, s77
  buffer_load_dwordx4 v[104:107], v8, s[36:39], s84 offen offset:0 nt
  buffer_load_dwordx4 v[240:243], v11, s[56:59], s80 offen offset:512 nt
  v_and_b32_dpp v26, v18, v4 row_newbcast:10 row_mask:0xf bank_mask:0xf
  v_and_b32_dpp v27, v18, v5 row_newbcast:10 row_mask:0xf bank_mask:0xf
  v_and_b32_dpp v28, v18, v6 row_newbcast:10 row_mask:0xf bank_mask:0xf
  v_and_b32_dpp v29, v18, v7 row_newbcast:10 row_mask:0xf bank_mask:0xf
  v_and_b32_dpp v30, v19, v4 row_newbcast:10 row_mask:0xf bank_mask:0xf
  v_and_b32_dpp v31, v19, v5 row_newbcast:10 row_mask:0xf bank_mask:0xf
  v_and_b32_dpp v32, v19, v6 row_newbcast:10 row_mask:0xf bank_mask:0xf
  v_and_b32_dpp v33, v19, v7 row_newbcast:10 row_mask:0xf bank_mask:0xf
  v_and_b32_dpp v34, v20, v4 row_newbcast:10 row_mask:0xf bank_mask:0xf
  v_and_b32_dpp v35, v20, v5 row_newbcast:10 row_mask:0xf bank_mask:0xf
  v_and_b32_dpp v36, v20, v6 row_newbcast:10 row_mask:0xf bank_mask:0xf
  v_and_b32_dpp v37, v20, v7 row_newbcast:10 row_mask:0xf bank_mask:0xf
  v_and_b32_dpp v38, v21, v4 row_newbcast:10 row_mask:0xf bank_mask:0xf
  v_and_b32_dpp v39, v21, v5 row_newbcast:10 row_mask:0xf bank_mask:0xf
  v_and_b32_dpp v40, v21, v6 row_newbcast:10 row_mask:0xf bank_mask:0xf
  v_and_b32_dpp v41, v21, v7 row_newbcast:10 row_mask:0xf bank_mask:0xf
  s_waitcnt vmcnt(2)
  v_mfma_f32_16x16x32_bf16 v[22:25], v[26:29], v[88:91], v[22:25]
  v_mfma_f32_16x16x32_bf16 v[22:25], v[30:33], v[92:95], v[22:25]
  v_mfma_f32_16x16x32_bf16 v[22:25], v[34:37], v[96:99], v[22:25]
  v_mfma_f32_16x16x32_bf16 v[22:25], v[38:41], v[100:103], v[22:25]
  buffer_load_dwordx4 v[108:111], v8, s[36:39], s84 offen offset:256 nt
  buffer_load_dwordx4 v[112:115], v8, s[36:39], s84 offen offset:512 nt
  buffer_load_dwordx4 v[116:119], v8, s[36:39], s84 offen offset:768 nt
  s_add_u32 s84, s89, 12
  s_and_b32 s84, s84, 15
  s_lshl_b32 s84, s84, 15
  s_add_u32 s84, s84, s77
  buffer_load_dwordx4 v[120:123], v8, s[36:39], s84 offen offset:0 nt
  buffer_load_dwordx4 v[244:247], v11, s[56:59], s80 offen offset:768 nt
  v_and_b32_dpp v26, v18, v4 row_newbcast:11 row_mask:0xf bank_mask:0xf
  v_and_b32_dpp v27, v18, v5 row_newbcast:11 row_mask:0xf bank_mask:0xf
  v_and_b32_dpp v28, v18, v6 row_newbcast:11 row_mask:0xf bank_mask:0xf
  v_and_b32_dpp v29, v18, v7 row_newbcast:11 row_mask:0xf bank_mask:0xf
  v_and_b32_dpp v30, v19, v4 row_newbcast:11 row_mask:0xf bank_mask:0xf
  v_and_b32_dpp v31, v19, v5 row_newbcast:11 row_mask:0xf bank_mask:0xf
  v_and_b32_dpp v32, v19, v6 row_newbcast:11 row_mask:0xf bank_mask:0xf
  v_and_b32_dpp v33, v19, v7 row_newbcast:11 row_mask:0xf bank_mask:0xf
  v_and_b32_dpp v34, v20, v4 row_newbcast:11 row_mask:0xf bank_mask:0xf
  v_and_b32_dpp v35, v20, v5 row_newbcast:11 row_mask:0xf bank_mask:0xf
  v_and_b32_dpp v36, v20, v6 row_newbcast:11 row_mask:0xf bank_mask:0xf
  v_and_b32_dpp v37, v20, v7 row_newbcast:11 row_mask:0xf bank_mask:0xf
  v_and_b32_dpp v38, v21, v4 row_newbcast:11 row_mask:0xf bank_mask:0xf
  v_and_b32_dpp v39, v21, v5 row_newbcast:11 row_mask:0xf bank_mask:0xf
  v_and_b32_dpp v40, v21, v6 row_newbcast:11 row_mask:0xf bank_mask:0xf
  v_and_b32_dpp v41, v21, v7 row_newbcast:11 row_mask:0xf bank_mask:0xf
  s_waitcnt vmcnt(2)
  v_mfma_f32_16x16x32_bf16 v[22:25], v[26:29], v[104:107], v[22:25]
  v_mfma_f32_16x16x32_bf16 v[22:25], v[30:33], v[108:111], v[22:25]
  v_mfma_f32_16x16x32_bf16 v[22:25], v[34:37], v[112:115], v[22:25]
  v_mfma_f32_16x16x32_bf16 v[22:25], v[38:41], v[116:119], v[22:25]
  buffer_load_dwordx4 v[124:127], v8, s[36:39], s84 offen offset:256 nt
  buffer_load_dwordx4 v[128:131], v8, s[36:39], s84 offen offset:512 nt
  buffer_load_dwordx4 v[132:135], v8, s[36:39], s84 offen offset:768 nt
  s_add_u32 s84, s89, 13
  s_and_b32 s84, s84, 15
  s_lshl_b32 s84, s84, 15
  s_add_u32 s84, s84, s77
  buffer_load_dwordx4 v[136:139], v8, s[36:39], s84 offen offset:0 nt
  buffer_load_dwordx4 v[248:251], v11, s[56:59], s80 offen offset:1024 nt
  buffer_load_dwordx4 v[48:51], off, s[68:71], s11 sc1
  v_and_b32_dpp v26, v18, v4 row_newbcast:12 row_mask:0xf bank_mask:0xf
  v_and_b32_dpp v27, v18, v5 row_newbcast:12 row_mask:0xf bank_mask:0xf
  v_and_b32_dpp v28, v18, v6 row_newbcast:12 row_mask:0xf bank_mask:0xf
  v_and_b32_dpp v29, v18, v7 row_newbcast:12 row_mask:0xf bank_mask:0xf
  v_and_b32_dpp v30, v19, v4 row_newbcast:12 row_mask:0xf bank_mask:0xf
  v_and_b32_dpp v31, v19, v5 row_newbcast:12 row_mask:0xf bank_mask:0xf
  v_and_b32_dpp v32, v19, v6 row_newbcast:12 row_mask:0xf bank_mask:0xf
  v_and_b32_dpp v33, v19, v7 row_newbcast:12 row_mask:0xf bank_mask:0xf
  v_and_b32_dpp v34, v20, v4 row_newbcast:12 row_mask:0xf bank_mask:0xf
  v_and_b32_dpp v35, v20, v5 row_newbcast:12 row_mask:0xf bank_mask:0xf
  v_and_b32_dpp v36, v20, v6 row_newbcast:12 row_mask:0xf bank_mask:0xf
  v_and_b32_dpp v37, v20, v7 row_newbcast:12 row_mask:0xf bank_mask:0xf
  v_and_b32_dpp v38, v21, v4 row_newbcast:12 row_mask:0xf bank_mask:0xf
  v_and_b32_dpp v39, v21, v5 row_newbcast:12 row_mask:0xf bank_mask:0xf
  v_and_b32_dpp v40, v21, v6 row_newbcast:12 row_mask:0xf bank_mask:0xf
  v_and_b32_dpp v41, v21, v7 row_newbcast:12 row_mask:0xf bank_mask:0xf
  s_waitcnt vmcnt(3)
  v_mfma_f32_16x16x32_bf16 v[22:25], v[26:29], v[120:123], v[22:25]
  v_mfma_f32_16x16x32_bf16 v[22:25], v[30:33], v[124:127], v[22:25]
  v_mfma_f32_16x16x32_bf16 v[22:25], v[34:37], v[128:131], v[22:25]
  v_mfma_f32_16x16x32_bf16 v[22:25], v[38:41], v[132:135], v[22:25]
  buffer_load_dwordx4 v[140:143], v8, s[36:39], s84 offen offset:256 nt
  buffer_load_dwordx4 v[144:147], v8, s[36:39], s84 offen offset:512 nt
  buffer_load_dwordx4 v[148:151], v8, s[36:39], s84 offen offset:768 nt
  s_add_u32 s84, s89, 14
  s_and_b32 s84, s84, 15
  s_lshl_b32 s84, s84, 15
  s_add_u32 s84, s84, s77
  buffer_load_dwordx4 v[56:59], v8, s[36:39], s84 offen offset:0 nt
  v_and_b32_dpp v26, v18, v4 row_newbcast:13 row_mask:0xf bank_mask:0xf
  v_and_b32_dpp v27, v18, v5 row_newbcast:13 row_mask:0xf bank_mask:0xf
  v_and_b32_dpp v28, v18, v6 row_newbcast:13 row_mask:0xf bank_mask:0xf
  v_and_b32_dpp v29, v18, v7 row_newbcast:13 row_mask:0xf bank_mask:0xf
  v_and_b32_dpp v30, v19, v4 row_newbcast:13 row_mask:0xf bank_mask:0xf
  v_and_b32_dpp v31, v19, v5 row_newbcast:13 row_mask:0xf bank_mask:0xf
  v_and_b32_dpp v32, v19, v6 row_newbcast:13 row_mask:0xf bank_mask:0xf
  v_and_b32_dpp v33, v19, v7 row_newbcast:13 row_mask:0xf bank_mask:0xf
  v_and_b32_dpp v34, v20, v4 row_newbcast:13 row_mask:0xf bank_mask:0xf
  v_and_b32_dpp v35, v20, v5 row_newbcast:13 row_mask:0xf bank_mask:0xf
  v_and_b32_dpp v36, v20, v6 row_newbcast:13 row_mask:0xf bank_mask:0xf
  v_and_b32_dpp v37, v20, v7 row_newbcast:13 row_mask:0xf bank_mask:0xf
  v_and_b32_dpp v38, v21, v4 row_newbcast:13 row_mask:0xf bank_mask:0xf
  v_and_b32_dpp v39, v21, v5 row_newbcast:13 row_mask:0xf bank_mask:0xf
  v_and_b32_dpp v40, v21, v6 row_newbcast:13 row_mask:0xf bank_mask:0xf
  v_and_b32_dpp v41, v21, v7 row_newbcast:13 row_mask:0xf bank_mask:0xf
  s_waitcnt vmcnt(1)
  v_mfma_f32_16x16x32_bf16 v[22:25], v[26:29], v[136:139], v[22:25]
  v_mfma_f32_16x16x32_bf16 v[22:25], v[30:33], v[140:143], v[22:25]
  v_mfma_f32_16x16x32_bf16 v[22:25], v[34:37], v[144:147], v[22:25]
  v_mfma_f32_16x16x32_bf16 v[22:25], v[38:41], v[148:151], v[22:25]
  buffer_load_dwordx4 v[60:63], v8, s[36:39], s84 offen offset:256 nt
  buffer_load_dwordx4 v[64:67], v8, s[36:39], s84 offen offset:512 nt
  buffer_load_dwordx4 v[68:71], v8, s[36:39], s84 offen offset:768 nt
  s_add_u32 s84, s89, 15
  s_and_b32 s84, s84, 15
  s_lshl_b32 s84, s84, 15
  s_add_u32 s84, s84, s77
  buffer_load_dwordx4 v[72:75], v8, s[36:39], s84 offen offset:0 nt
  v_and_b32_dpp v26, v18, v4 row_newbcast:14 row_mask:0xf bank_mask:0xf
  v_and_b32_dpp v27, v18, v5 row_newbcast:14 row_mask:0xf bank_mask:0xf
  v_and_b32_dpp v28, v18, v6 row_newbcast:14 row_mask:0xf bank_mask:0xf
  v_and_b32_dpp v29, v18, v7 row_newbcast:14 row_mask:0xf bank_mask:0xf
  v_and_b32_dpp v30, v19, v4 row_newbcast:14 row_mask:0xf bank_mask:0xf
  v_and_b32_dpp v31, v19, v5 row_newbcast:14 row_mask:0xf bank_mask:0xf
  v_and_b32_dpp v32, v19, v6 row_newbcast:14 row_mask:0xf bank_mask:0xf
  v_and_b32_dpp v33, v19, v7 row_newbcast:14 row_mask:0xf bank_mask:0xf
  v_and_b32_dpp v34, v20, v4 row_newbcast:14 row_mask:0xf bank_mask:0xf
  v_and_b32_dpp v35, v20, v5 row_newbcast:14 row_mask:0xf bank_mask:0xf
  v_and_b32_dpp v36, v20, v6 row_newbcast:14 row_mask:0xf bank_mask:0xf
  v_and_b32_dpp v37, v20, v7 row_newbcast:14 row_mask:0xf bank_mask:0xf
  v_and_b32_dpp v38, v21, v4 row_newbcast:14 row_mask:0xf bank_mask:0xf
  v_and_b32_dpp v39, v21, v5 row_newbcast:14 row_mask:0xf bank_mask:0xf
  v_and_b32_dpp v40, v21, v6 row_newbcast:14 row_mask:0xf bank_mask:0xf
  v_and_b32_dpp v41, v21, v7 row_newbcast:14 row_mask:0xf bank_mask:0xf
  s_waitcnt vmcnt(1)
  v_mfma_f32_16x16x32_bf16 v[22:25], v[26:29], v[56:59], v[22:25]
  v_mfma_f32_16x16x32_bf16 v[22:25], v[30:33], v[60:63], v[22:25]
  v_mfma_f32_16x16x32_bf16 v[22:25], v[34:37], v[64:67], v[22:25]
  v_mfma_f32_16x16x32_bf16 v[22:25], v[38:41], v[68:71], v[22:25]
  buffer_load_dwordx4 v[76:79], v8, s[36:39], s84 offen offset:256 nt
  buffer_load_dwordx4 v[80:83], v8, s[36:39], s84 offen offset:512 nt
  buffer_load_dwordx4 v[84:87], v8, s[36:39], s84 offen offset:768 nt
  v_xor_b32 v54, s90, v50
  v_xor_b32 v55, s91, v51
  v_or_b32 v54, v54, v55
  v_cmp_ne_u32 vcc, 0, v54
  s_nop 4
  s_cmp_eq_u64 vcc, 0
  s_cbranch_scc1 L_ml_ok_11
  s_mov_b32 s16, 40000
L_ml_spin_10:
  s_sleep 2
  buffer_load_dwordx4 v[48:51], off, s[68:71], s11 sc1
  s_waitcnt vmcnt(0)
  s_sub_u32 s16, s16, 1
  s_cmp_eq_u32 s16, 0
  s_cbranch_scc1 L_ml_ok_11
  v_xor_b32 v54, s90, v50
  v_xor_b32 v55, s91, v51
  v_or_b32 v54, v54, v55
  v_cmp_ne_u32 vcc, 0, v54
  s_nop 4
  s_cmp_eq_u64 vcc, 0
  s_cbranch_scc0 L_ml_spin_10
L_ml_ok_11:
  v_mov_b32 v54, 0
  s_mov_b32 s16, 40000
L_st_spin_12:
  ds_read_b32 v55, v54 offset:12416
  s_waitcnt lgkmcnt(0)
  v_readfirstlane_b32 s82, v55
  s_nop 2
  s_cmp_ge_u32 s82, 8
  s_cbranch_scc1 L_st_ok_13
  s_sub_u32 s16, s16, 1
  s_cmp_eq_u32 s16, 0
  s_cbranch_scc1 L_st_ok_13
  s_sleep 2
  s_branch L_st_spin_12
L_st_ok_13:
  v_lshrrev_b32 v34, 2, v2
  v_lshlrev_b32 v34, 4, v34
  ds_read_b128 v[26:29], v34 offset:12352
  s_waitcnt lgkmcnt(0)
  v_max_f32 v30, v26, v28
  s_nop 1
  v_max_f32_dpp v30, v30, v30 row_ror:4 row_mask:0xf bank_mask:0xf
  s_nop 1
  v_max_f32_dpp v30, v30, v30 row_ror:8 row_mask:0xf bank_mask:0xf
  s_nop 1
  v_sub_f32 v31, v26, v30
  v_sub_f32 v32, v28, v30
  v_mul_f32 v31, 0x3fb8aa3b, v31
  v_mul_f32 v32, 0x3fb8aa3b, v32
  v_exp_f32 v31, v31
  v_exp_f32 v32, v32
  s_nop 0
  v_mul_f32 v31, v31, v27
  v_fmac_f32 v31, v32, v29
  s_nop 1
  v_add_f32_dpp v31, v31, v31 row_ror:4 row_mask:0xf bank_mask:0xf
  s_nop 1
  v_add_f32_dpp v31, v31, v31 row_ror:8 row_mask:0xf bank_mask:0xf
  s_nop 1
  v_max_f32 v32, v30, v48
  v_sub_f32 v33, v30, v32
  v_sub_f32 v34, v48, v32
  v_sub_f32 v35, v52, v32
  v_mul_f32 v33, 0x3fb8aa3b, v33
  v_mul_f32 v34, 0x3fb8aa3b, v34
  v_mul_f32 v35, 0x3fb8aa3b, v35
  v_exp_f32 v33, v33
  v_exp_f32 v34, v34
  v_exp_f32 v35, v35
  s_nop 0
  v_mul_f32 v31, v31, v33
  v_fmac_f32 v31, v49, v34
  v_rcp_f32 v31, v31
  s_nop 0
  v_mul_f32 v53, v31, v35
  v_and_b32_dpp v26, v18, v4 row_newbcast:15 row_mask:0xf bank_mask:0xf
  v_and_b32_dpp v27, v18, v5 row_newbcast:15 row_mask:0xf bank_mask:0xf
  v_and_b32_dpp v28, v18, v6 row_newbcast:15 row_mask:0xf bank_mask:0xf
  v_and_b32_dpp v29, v18, v7 row_newbcast:15 row_mask:0xf bank_mask:0xf
  v_and_b32_dpp v30, v19, v4 row_newbcast:15 row_mask:0xf bank_mask:0xf
  v_and_b32_dpp v31, v19, v5 row_newbcast:15 row_mask:0xf bank_mask:0xf
  v_and_b32_dpp v32, v19, v6 row_newbcast:15 row_mask:0xf bank_mask:0xf
  v_and_b32_dpp v33, v19, v7 row_newbcast:15 row_mask:0xf bank_mask:0xf
  v_and_b32_dpp v34, v20, v4 row_newbcast:15 row_mask:0xf bank_mask:0xf
  v_and_b32_dpp v35, v20, v5 row_newbcast:15 row_mask:0xf bank_mask:0xf
  v_and_b32_dpp v36, v20, v6 row_newbcast:15 row_mask:0xf bank_mask:0xf
  v_and_b32_dpp v37, v20, v7 row_newbcast:15 row_mask:0xf bank_mask:0xf
  v_and_b32_dpp v38, v21, v4 row_newbcast:15 row_mask:0xf bank_mask:0xf
  v_and_b32_dpp v39, v21, v5 row_newbcast:15 row_mask:0xf bank_mask:0xf
  v_and_b32_dpp v40, v21, v6 row_newbcast:15 row_mask:0xf bank_mask:0xf
  v_and_b32_dpp v41, v21, v7 row_newbcast:15 row_mask:0xf bank_mask:0xf
  s_waitcnt vmcnt(0)
  v_mfma_f32_16x16x32_bf16 v[22:25], v[26:29], v[72:75], v[22:25]
  v_mfma_f32_16x16x32_bf16 v[22:25], v[30:33], v[76:79], v[22:25]
  v_mfma_f32_16x16x32_bf16 v[22:25], v[34:37], v[80:83], v[22:25]
  v_mfma_f32_16x16x32_bf16 v[22:25], v[38:41], v[84:87], v[22:25]
  s_lshl_b32 s82, s72, 9
  v_lshlrev_b32 v43, 5, v2
  v_lshl_add_u32 v43, v3, 4, v43
  v_add_u32 v43, s82, v43
  v_lshrrev_b32 v34, 2, v2
  v_and_b32 v36, 3, v2
  v_lshl_add_u32 v36, v3, 2, v36
  v_lshlrev_b32 v36, 2, v36
  v_lshl_add_u32 v36, v34, 10, v36
  s_lshl_b32 s82, s72, 6
  v_add_u32 v36, s82, v36
  s_nop 3
  v_mul_f32 v22, v22, v53
  v_mul_f32 v23, v23, v53
  v_mul_f32 v24, v24, v53
  v_mul_f32 v25, v25, v53
  s_mov_b32 exec_lo, -1
  s_mov_b32 exec_hi, 0
  ds_write_b128 v43, v[22:25] offset:40960
  s_mov_b64 exec, -1
  v_and_b32 v48, v47, v4
  v_and_b32 v49, v47, v5
  v_and_b32 v50, v47, v6
  v_and_b32 v51, v47, v7
  s_nop 0
  s_nop 0
  v_mfma_f32_16x16x32_bf16 v[56:59], v[48:51], v[232:235], 0
  v_mfma_f32_16x16x32_bf16 v[60:63], v[48:51], v[236:239], 0
  v_mfma_f32_16x16x32_bf16 v[64:67], v[48:51], v[240:243], 0
  v_mfma_f32_16x16x32_bf16 v[68:71], v[48:51], v[244:247], 0
  v_mfma_f32_16x16x32_bf16 v[72:75], v[48:51], v[248:251], 0
  s_waitcnt lgkmcnt(0)
  s_barrier
  ds_read_b32 v37, v36 offset:40960
  ds_read_b32 v38, v36 offset:41472
  s_waitcnt lgkmcnt(0)
  v_add_f32 v54, v37, v38
  s_nop 1
  v_add_f32_dpp v54, v54, v54 row_ror:4 row_mask:0xf bank_mask:0xf
  s_nop 1
  v_add_f32_dpp v54, v54, v54 row_ror:8 row_mask:0xf bank_mask:0xf
  s_nop 1
  v_cvt_pk_bf16_f32 v54, v54, v54
  s_nop 1
  v_and_b32_dpp v26, v54, v4 row_newbcast:0 row_mask:0xf bank_mask:0xf
  v_and_b32_dpp v27, v54, v5 row_newbcast:0 row_mask:0xf bank_mask:0xf
  v_and_b32_dpp v28, v54, v6 row_newbcast:0 row_mask:0xf bank_mask:0xf
  v_and_b32_dpp v29, v54, v7 row_newbcast:0 row_mask:0xf bank_mask:0xf
  v_and_b32_dpp v30, v54, v4 row_newbcast:1 row_mask:0xf bank_mask:0xf
  v_and_b32_dpp v31, v54, v5 row_newbcast:1 row_mask:0xf bank_mask:0xf
  v_and_b32_dpp v32, v54, v6 row_newbcast:1 row_mask:0xf bank_mask:0xf
  v_and_b32_dpp v33, v54, v7 row_newbcast:1 row_mask:0xf bank_mask:0xf
  v_mfma_f32_16x16x32_bf16 v[56:59], v[26:29], v[152:155], v[56:59]
  v_mfma_f32_16x16x32_bf16 v[60:63], v[26:29], v[156:159], v[60:63]
  v_mfma_f32_16x16x32_bf16 v[64:67], v[26:29], v[160:163], v[64:67]
  v_mfma_f32_16x16x32_bf16 v[68:71], v[26:29], v[164:167], v[68:71]
  v_mfma_f32_16x16x32_bf16 v[72:75], v[26:29], v[168:171], v[72:75]
  v_and_b32_dpp v34, v54, v4 row_newbcast:2 row_mask:0xf bank_mask:0xf
  v_and_b32_dpp v35, v54, v5 row_newbcast:2 row_mask:0xf bank_mask:0xf
  v_and_b32_dpp v36, v54, v6 row_newbcast:2 row_mask:0xf bank_mask:0xf
  v_and_b32_dpp v37, v54, v7 row_newbcast:2 row_mask:0xf bank_mask:0xf
  v_mfma_f32_16x16x32_bf16 v[56:59], v[30:33], v[172:175], v[56:59]
  v_mfma_f32_16x16x32_bf16 v[60:63], v[30:33], v[176:179], v[60:63]
  v_mfma_f32_16x16x32_bf16 v[64:67], v[30:33], v[180:183], v[64:67]
  v_mfma_f32_16x16x32_bf16 v[68:71], v[30:33], v[184:187], v[68:71]
  v_mfma_f32_16x16x32_bf16 v[72:75], v[30:33], v[188:191], v[72:75]
  v_and_b32_dpp v38, v54, v4 row_newbcast:3 row_mask:0xf bank_mask:0xf
  v_and_b32_dpp v39, v54, v5 row_newbcast:3 row_mask:0xf bank_mask:0xf
  v_and_b32_dpp v40, v54, v6 row_newbcast:3 row_mask:0xf bank_mask:0xf
  v_and_b32_dpp v41, v54, v7 row_newbcast:3 row_mask:0xf bank_mask:0xf
  v_mfma_f32_16x16x32_bf16 v[56:59], v[34:37], v[192:195], v[56:59]
  v_mfma_f32_16x16x32_bf16 v[60:63], v[34:37], v[196:199], v[60:63]
  v_mfma_f32_16x16x32_bf16 v[64:67], v[34:37], v[200:203], v[64:67]
  v_mfma_f32_16x16x32_bf16 v[68:71], v[34:37], v[204:207], v[68:71]
  v_mfma_f32_16x16x32_bf16 v[72:75], v[34:37], v[208:211], v[72:75]
  v_mfma_f32_16x16x32_bf16 v[56:59], v[38:41], v[212:215], v[56:59]
  v_mfma_f32_16x16x32_bf16 v[60:63], v[38:41], v[216:219], v[60:63]
  v_mfma_f32_16x16x32_bf16 v[64:67], v[38:41], v[220:223], v[64:67]
  v_mfma_f32_16x16x32_bf16 v[68:71], v[38:41], v[224:227], v[68:71]
  v_mfma_f32_16x16x32_bf16 v[72:75], v[38:41], v[228:231], v[72:75]
  s_mul_i32 s82, s72, 2560
  v_lshlrev_b32 v43, 5, v2
  v_lshl_add_u32 v43, v3, 4, v43
  v_add_u32 v43, s82, v43
  s_nop 4
  s_mov_b32 exec_lo, -1
  s_mov_b32 exec_hi, 0
  ds_write_b128 v43, v[56:59] offset:20480
  ds_write_b128 v43, v[60:63] offset:20992
  ds_write_b128 v43, v[64:67] offset:21504
  ds_write_b128 v43, v[68:71] offset:22016
  ds_write_b128 v43, v[72:75] offset:22528
  s_mov_b64 exec, -1
  s_waitcnt lgkmcnt(0)
  s_barrier
  s_cmp_ge_u32 s72, 5
  s_cbranch_scc1 L_cons
  v_lshlrev_b32 v42, 3, v0
  v_lshlrev_b32 v43, 4, v0
  ds_read_b64 v[88:89], v42 offset:20480
  ds_read_b64 v[90:91], v42 offset:23040
  ds_read_b64 v[92:93], v42 offset:25600
  ds_read_b64 v[94:95], v42 offset:28160
  ds_read_b64 v[96:97], v42 offset:30720
  ds_read_b64 v[98:99], v42 offset:33280
  ds_read_b64 v[100:101], v42 offset:35840
  ds_read_b64 v[102:103], v42 offset:38400
  s_waitcnt lgkmcnt(0)
  v_pk_add_f32 v[88:89], v[88:89], v[96:97]
  v_pk_add_f32 v[90:91], v[90:91], v[98:99]
  v_pk_add_f32 v[92:93], v[92:93], v[100:101]
  v_pk_add_f32 v[94:95], v[94:95], v[102:103]
  v_pk_add_f32 v[88:89], v[88:89], v[92:93]
  v_pk_add_f32 v[90:91], v[90:91], v[94:95]
  v_pk_add_f32 v[88:89], v[88:89], v[90:91]
  v_mov_b32 v90, s90
  v_mov_b32 v91, s91
  buffer_store_dwordx4 v[88:91], v43, s[68:71], s13 offen sc1
  s_branch L_fin
L_cons:
  s_cmp_lg_u32 s72, 5
  s_cbranch_scc1 L_fin
  s_cmp_ge_u32 s76, 40
  s_cbranch_scc1 L_fin
  v_lshrrev_b32 v42, 3, v1
  v_mul_u32_u24 v42, 5120, v42
  v_and_b32 v43, 7, v1
  v_lshl_add_u32 v42, v43, 4, v42
  s_mul_i32 s82, s74, 327680
  s_lshl_b32 s83, s76, 7
  s_add_u32 s86, s82, s83
  s_mul_i32 s83, s74, 1280
  s_lshl_b32 s85, s76, 5
  s_add_u32 s83, s83, s85
  v_lshlrev_b32 v44, 2, v43
  buffer_load_dword v45, v44, s[28:31], s83 offen
  s_mov_b32 s16, 40000
  s_add_u32 s85, s86, 0
  buffer_load_dwordx4 v[88:91], v42, s[68:71], s85 offen sc1
  s_add_u32 s85, s86, 40960
  buffer_load_dwordx4 v[92:95], v42, s[68:71], s85 offen sc1
  s_add_u32 s85, s86, 81920
  buffer_load_dwordx4 v[96:99], v42, s[68:71], s85 offen sc1
  s_add_u32 s85, s86, 122880
  buffer_load_dwordx4 v[100:103], v42, s[68:71], s85 offen sc1
  s_add_u32 s85, s86, 163840
  buffer_load_dwordx4 v[104:107], v42, s[68:71], s85 offen sc1
  s_add_u32 s85, s86, 204800
  buffer_load_dwordx4 v[108:111], v42, s[68:71], s85 offen sc1
  s_add_u32 s85, s86, 245760
  buffer_load_dwordx4 v[112:115], v42, s[68:71], s85 offen sc1
  s_add_u32 s85, s86, 286720
  buffer_load_dwordx4 v[116:119], v42, s[68:71], s85 offen sc1
L_poll:
  s_sleep 2
  s_add_u32 s85, s86, 0
  buffer_load_dwordx4 v[120:123], v42, s[68:71], s85 offen sc1
  s_add_u32 s85, s86, 40960
  buffer_load_dwordx4 v[124:127], v42, s[68:71], s85 offen sc1
  s_add_u32 s85, s86, 81920
  buffer_load_dwordx4 v[128:131], v42, s[68:71], s85 offen sc1
  s_add_u32 s85, s86, 122880
  buffer_load_dwordx4 v[132:135], v42, s[68:71], s85 offen sc1
  s_add_u32 s85, s86, 163840
  buffer_load_dwordx4 v[136:139], v42, s[68:71], s85 offen sc1
  s_add_u32 s85, s86, 204800
  buffer_load_dwordx4 v[140:143], v42, s[68:71], s85 offen sc1
  s_add_u32 s85, s86, 245760
  buffer_load_dwordx4 v[144:147], v42, s[68:71], s85 offen sc1
  s_add_u32 s85, s86, 286720
  buffer_load_dwordx4 v[148:151], v42, s[68:71], s85 offen sc1
  s_waitcnt vmcnt(8)
  v_xor_b32 v54, s90, v90
  v_xor_b32 v55, s91, v91
  v_or_b32 v54, v54, v55
  v_xor_b32 v55, s90, v94
  v_or_b32 v54, v54, v55
  v_xor_b32 v55, s91, v95
  v_or_b32 v54, v54, v55
  v_xor_b32 v55, s90, v98
  v_or_b32 v54, v54, v55
  v_xor_b32 v55, s91, v99
  v_or_b32 v54, v54, v55
  v_xor_b32 v55, s90, v102
  v_or_b32 v54, v54, v55
  v_xor_b32 v55, s91, v103
  v_or_b32 v54, v54, v55
  v_xor_b32 v55, s90, v106
  v_or_b32 v54, v54, v55
  v_xor_b32 v55, s91, v107
  v_or_b32 v54, v54, v55
  v_xor_b32 v55, s90, v110
  v_or_b32 v54, v54, v55
  v_xor_b32 v55, s91, v111
  v_or_b32 v54, v54, v55
  v_xor_b32 v55, s90, v114
  v_or_b32 v54, v54, v55
  v_xor_b32 v55, s91, v115
  v_or_b32 v54, v54, v55
  v_xor_b32 v55, s90, v118
  v_or_b32 v54, v54, v55
  v_xor_b32 v55, s91, v119
  v_or_b32 v54, v54, v55
  v_cmp_ne_u32 vcc, 0, v54
  s_nop 4
  s_cmp_eq_u64 vcc, 0
  s_cbranch_scc1 L_polledA
  s_sleep 2
  s_add_u32 s85, s86, 0
  buffer_load_dwordx4 v[88:91], v42, s[68:71], s85 offen sc1
  s_add_u32 s85, s86, 40960
  buffer_load_dwordx4 v[92:95], v42, s[68:71], s85 offen sc1
  s_add_u32 s85, s86, 81920
  buffer_load_dwordx4 v[96:99], v42, s[68:71], s85 offen sc1
  s_add_u32 s85, s86, 122880
  buffer_load_dwordx4 v[100:103], v42, s[68:71], s85 offen sc1
  s_add_u32 s85, s86, 163840
  buffer_load_dwordx4 v[104:107], v42, s[68:71], s85 offen sc1
  s_add_u32 s85, s86, 204800
  buffer_load_dwordx4 v[108:111], v42, s[68:71], s85 offen sc1
  s_add_u32 s85, s86, 245760
  buffer_load_dwordx4 v[112:115], v42, s[68:71], s85 offen sc1
  s_add_u32 s85, s86, 286720
  buffer_load_dwordx4 v[116:119], v42, s[68:71], s85 offen sc1
  s_waitcnt vmcnt(8)
  v_xor_b32 v54, s90, v122
  v_xor_b32 v55, s91, v123
  v_or_b32 v54, v54, v55
  v_xor_b32 v55, s90, v126
  v_or_b32 v54, v54, v55
  v_xor_b32 v55, s91, v127
  v_or_b32 v54, v54, v55
  v_xor_b32 v55, s90, v130
  v_or_b32 v54, v54, v55
  v_xor_b32 v55, s91, v131
  v_or_b32 v54, v54, v55
  v_xor_b32 v55, s90, v134
  v_or_b32 v54, v54, v55
  v_xor_b32 v55, s91, v135
  v_or_b32 v54, v54, v55
  v_xor_b32 v55, s90, v138
  v_or_b32 v54, v54, v55
  v_xor_b32 v55, s91, v139
  v_or_b32 v54, v54, v55
  v_xor_b32 v55, s90, v142
  v_or_b32 v54, v54, v55
  v_xor_b32 v55, s91, v143
  v_or_b32 v54, v54, v55
  v_xor_b32 v55, s90, v146
  v_or_b32 v54, v54, v55
  v_xor_b32 v55, s91, v147
  v_or_b32 v54, v54, v55
  v_xor_b32 v55, s90, v150
  v_or_b32 v54, v54, v55
  v_xor_b32 v55, s91, v151
  v_or_b32 v54, v54, v55
  v_cmp_ne_u32 vcc, 0, v54
  s_nop 4
  s_cmp_eq_u64 vcc, 0
  s_cbranch_scc1 L_polledB
  s_sub_u32 s16, s16, 1
  s_cmp_lg_u32 s16, 0
  s_cbranch_scc1 L_poll
L_polledB:
  v_pk_add_f32 v[120:121], v[120:121], v[136:137]
  v_pk_add_f32 v[124:125], v[124:125], v[140:141]
  v_pk_add_f32 v[128:129], v[128:129], v[144:145]
  v_pk_add_f32 v[132:133], v[132:133], v[148:149]
  v_pk_add_f32 v[120:121], v[120:121], v[128:129]
  v_pk_add_f32 v[124:125], v[124:125], v[132:133]
  v_pk_add_f32 v[120:121], v[120:121], v[124:125]
  v_mov_b32 v26, v120
  v_mov_b32 v27, v121
  s_branch L_polled
L_polledA:
  v_pk_add_f32 v[88:89], v[88:89], v[104:105]
  v_pk_add_f32 v[92:93], v[92:93], v[108:109]
  v_pk_add_f32 v[96:97], v[96:97], v[112:113]
  v_pk_add_f32 v[100:101], v[100:101], v[116:117]
  v_pk_add_f32 v[88:89], v[88:89], v[96:97]
  v_pk_add_f32 v[92:93], v[92:93], v[100:101]
  v_pk_add_f32 v[88:89], v[88:89], v[92:93]
  v_mov_b32 v26, v88
  v_mov_b32 v27, v89
L_polled:
  s_nop 1
  v_add_f32_dpp v26, v26, v26 row_ror:8 row_mask:0xf bank_mask:0xf
  v_add_f32_dpp v27, v27, v27 row_ror:8 row_mask:0xf bank_mask:0xf
  s_nop 0
  v_mov_b32 v54, v26
  s_nop 1
  v_permlane16_swap_b32 v26, v54
  s_nop 0
  v_add_f32 v26, v26, v54
  v_mov_b32 v54, v26
  s_nop 1
  v_permlane32_swap_b32 v26, v54
  s_nop 0
  v_add_f32 v26, v26, v54
  v_mov_b32 v54, v27
  s_nop 1
  v_permlane16_swap_b32 v27, v54
  s_nop 0
  v_add_f32 v27, v27, v54
  v_mov_b32 v54, v27
  s_nop 1
  v_permlane32_swap_b32 v27, v54
  s_nop 0
  v_add_f32 v27, v27, v54
  v_lshlrev_b32 v54, 16, v45
  v_and_b32 v55, 0xffff0000, v45
  v_add_f32 v26, v26, v54
  v_add_f32 v27, v27, v55
  v_cvt_pk_bf16_f32 v26, v26, v27
  s_mov_b64 exec, 0xff
  buffer_store_dword v26, v44, s[60:63], s83 offen
L_fin:
L_end:
  s_endpgm
.section .rodata,"a"
.p2align 6
.amdhsa_kernel parallel_sum__gqa_block_cached__geglu_ffn__decode_kernel
  .amdhsa_next_free_vgpr 252
  .amdhsa_next_free_sgpr 96
  .amdhsa_accum_offset 252
  .amdhsa_group_segment_fixed_size 0
  .amdhsa_kernarg_size 96
  .amdhsa_user_sgpr_count 2
  .amdhsa_user_sgpr_kernarg_segment_ptr 1
  .amdhsa_system_sgpr_workgroup_id_x 1
  .amdhsa_float_denorm_mode_32 3
  .amdhsa_float_denorm_mode_16_64 3
.end_amdhsa_kernel
```
